```python
import torch

def _softmax(x, axis=-1):
    return torch.softmax(x, dim=axis)
def _gelu(x):
    return torch.nn.functional.gelu(x, approximate="tanh")
def _silu(x):
    return torch.nn.functional.silu(x)
def _sigmoid(x):
    return torch.sigmoid(x)
def _layernorm(x, axis=-1, eps=1e-5):
    m = x.mean(dim=axis, keepdim=True)
    v = x.var(dim=axis, keepdim=True, unbiased=False)
    return (x - m) / torch.sqrt(v + eps)
def _scatter_add(tgt, idx, src, axis=0):
    return tgt.clone().index_add_(axis, idx, src)
def _segment_sum(src, seg, n):
    out = torch.zeros((n,) + src.shape[1:], dtype=src.dtype)
    return out.index_add_(0, seg, src)
def _pad(x, pw):
    flat = tuple(v for pair in reversed(pw) for v in pair)
    return torch.nn.functional.pad(x, flat)

kernel_name = 'sequential_preLN__mha_block__dense_activation_squared_relu__prompt'

def setup_inputs():

    _w = (lambda a: (lambda t: t.to(torch.bfloat16) if t.is_floating_point() else t)(torch.as_tensor(a)))
    def _A_setup():
        B, S, D, H = 1, 2048, 640, 32
        return {
            "x": _w((lambda *s: torch.randn(*s, dtype=torch.bfloat16) * 0.05)(B, S, D)),
            "wqkv": _w((lambda *s: torch.randn(*s, dtype=torch.bfloat16) * 0.05)(D, 3 * D)),
            "wo": _w((lambda *s: torch.randn(*s, dtype=torch.bfloat16) * 0.05)(D, D)),
        }
    _A_in = _A_setup()

    def _B_setup():
        B, S, D, F = 1, 2048, 640, 1536
        return {
            "x": _w((lambda *s: torch.randn(*s, dtype=torch.bfloat16) * 0.05)(B, S, D)),
            "w1": _w((lambda *s: torch.randn(*s, dtype=torch.bfloat16) * 0.05)(D, F)),
            "b1": _w((lambda *s: torch.randn(*s, dtype=torch.bfloat16) * 0.8)(F)),
            "w2": _w((lambda *s: torch.randn(*s, dtype=torch.bfloat16) * 0.05)(F, D)),
            "b2": _w((lambda *s: torch.randn(*s, dtype=torch.bfloat16) * 3.2)(D)),
        }
    _B_in = _B_setup()

    return {
        "A_x": _A_in["x"],
        "A_wqkv": _A_in["wqkv"],
        "A_wo": _A_in["wo"],
        "B_x": _B_in["x"],
        "B_w1": _B_in["w1"],
        "B_b1": _B_in["b1"],
        "B_w2": _B_in["w2"],
        "B_b2": _B_in["b2"],
    }

def reference(A_x, A_wqkv, A_wo, B_x, B_w1, B_b1, B_w2, B_b2):
    def _A_ref(x, wqkv, wo):
        B, S, D = x.shape
        H = 32
        Dh = D // H
        qkv = (lambda x, *d: x.permute(*d))((x @ wqkv).reshape(B, S, 3, H, Dh), 2, 0, 3, 1, 4)
        q, k, v = qkv[0], qkv[1], qkv[2]
        scores = torch.einsum("bhqd,bhkd->bhqk", q, k) * (Dh ** -0.5)
        p = _softmax(scores, axis=-1)
        o = torch.einsum("bhqk,bhkd->bhqd", p, v)
        return (lambda x, *d: x.permute(*d))(o, 0, 2, 1, 3).reshape(B, S, D) @ wo

    def _B_ref(x, w1, b1, w2, b2):
        h = torch.einsum("bsd,df->bsf", x, w1) + b1
        zero = torch.zeros_like(h)
        r = torch.where(h > zero, h, zero)
        h = r * r
        out = torch.einsum("bsf,fd->bsd", h, w2) + b2
        return out

    x = A_x
    h = x + _A_ref(_layernorm(x, axis=-1), A_wqkv, A_wo)
    h2 = h + _B_ref(_layernorm(h, axis=-1), B_w1, B_b1, B_w2, B_b2)
    return h2
```

```asm
; @launch grid=(256,1,1) block=(512,1,1) lds=163840
.amdgcn_target "amdgcn-amd-amdhsa--gfx950"
.text
.globl sequential_preLN__mha_block__dense_activation_squared_relu__prompt_kernel
.p2align 8
.type sequential_preLN__mha_block__dense_activation_squared_relu__prompt_kernel,@function
sequential_preLN__mha_block__dense_activation_squared_relu__prompt_kernel:
    s_cmp_ge_u32 s2, 256
    s_cbranch_scc1 L_end
    s_load_dwordx2 s[4:5], s[0:1], 0
    s_load_dwordx2 s[8:9], s[0:1], 8
    s_load_dwordx2 s[24:25], s[0:1], 80
    s_load_dwordx2 s[32:33], s[0:1], 72
    s_load_dwordx2 s[12:13], s[0:1], 16
    s_load_dwordx2 s[16:17], s[0:1], 32
    s_load_dwordx2 s[36:37], s[0:1], 40
    s_load_dwordx2 s[20:21], s[0:1], 48
    s_load_dwordx2 s[40:41], s[0:1], 56
    s_load_dwordx2 s[28:29], s[0:1], 64
    s_mov_b32 s6, 2621440
    s_mov_b32 s7, 0x00020000
    s_mov_b32 s10, 2457600
    s_mov_b32 s11, 0x00020000
    s_mov_b32 s26, 268435456
    s_mov_b32 s27, 0x00020000
    s_mov_b32 s34, 256
    s_mov_b32 s35, 0x00020000
    s_mov_b32 s14, 819200
    s_mov_b32 s15, 0x00020000
    s_mov_b32 s18, 1966080
    s_mov_b32 s19, 0x00020000
    s_mov_b32 s38, 3072
    s_mov_b32 s39, 0x00020000
    s_mov_b32 s22, 1966080
    s_mov_b32 s23, 0x00020000
    s_mov_b32 s42, 1280
    s_mov_b32 s43, 0x00020000
    s_mov_b32 s30, 2621440
    s_mov_b32 s31, 0x00020000
    v_and_b32 v1, 63, v0
    v_lshrrev_b32 v2, 6, v0
    s_nop 0
    v_readfirstlane_b32 s46, v2
    s_and_b32 s44, s2, 7
    s_lshr_b32 s45, s2, 3
    s_lshr_b32 s50, s45, 3
    s_and_b32 s51, s45, 7
    s_and_b32 s92, s45, 3
    s_lshl_b32 s93, s44, 2
    s_add_u32 s92, s92, s93
    s_lshr_b32 s93, s45, 2
    s_lshr_b32 s56, s44, 1
    s_lshl_b32 s56, s56, 2
    s_add_u32 s56, s56, s50
    s_and_b32 s57, s44, 1
    s_lshl_b32 s57, s57, 3
    s_add_u32 s57, s57, s51
    s_cmp_lt_u32 s46, 4
    s_cbranch_scc1 L_A_comp
    s_cmp_eq_u32 s57, 15
    s_cbranch_scc1 L_A_idle_h
    v_lshrrev_b32 v8, 3, v1
    v_mul_u32_u24 v8, 1280, v8
    v_and_b32 v9, 7, v1
    v_lshrrev_b32 v10, 4, v1
    v_xor_b32 v11, v9, v10
    v_lshl_add_u32 v2, v11, 4, v8
    v_xor_b32 v11, 4, v11
    v_lshl_add_u32 v3, v11, 4, v8
    v_mul_u32_u24 v8, 3840, v10
    v_and_b32 v9, 15, v1
    v_lshlrev_b32 v10, 2, v10
    v_xor_b32 v9, v9, v10
    v_lshl_add_u32 v4, v9, 4, v8
    s_sub_u32 s59, s46, 4
    s_lshl_b32 s63, s59, 12
    s_lshl_b32 s61, s56, 2
    s_add_u32 s61, s61, s59
    s_mul_i32 s61, s61, 40960
    s_mul_i32 s62, s59, 61440
    s_lshl_b32 s60, s57, 8
    s_add_u32 s62, s62, s60
    s_mul_i32 s59, s50, 3
    s_add_u32 s58, s51, s59
    s_cmp_ge_u32 s58, 10
    s_cselect_b32 s59, 10, 0
    s_sub_u32 s58, s58, s59
    s_mov_b32 s58, s44
    s_mov_b32 s65, s63
    s_mov_b32 s66, 0
    s_waitcnt lgkmcnt(0)
L_A_ld:
    s_lshl_b32 s59, s58, 7
    s_add_u32 s59, s59, s61
    s_mul_i32 s60, s58, 245760
    s_add_u32 s60, s60, s62
    s_add_u32 m0, s65, 0
    s_nop 0
    buffer_load_dwordx4 v2, s[4:7], s59 offen lds
    s_add_u32 m0, s65, 16384
    s_nop 0
    buffer_load_dwordx4 v4, s[8:11], s60 offen lds
    s_add_u32 s59, s59, 10240
    s_add_u32 s60, s60, 15360
    s_add_u32 m0, s65, 1024
    s_nop 0
    buffer_load_dwordx4 v3, s[4:7], s59 offen lds
    s_add_u32 m0, s65, 17408
    s_nop 0
    buffer_load_dwordx4 v4, s[8:11], s60 offen lds
    s_add_u32 s59, s59, 10240
    s_add_u32 s60, s60, 15360
    s_add_u32 m0, s65, 2048
    s_nop 0
    buffer_load_dwordx4 v2, s[4:7], s59 offen lds
    s_add_u32 m0, s65, 18432
    s_nop 0
    buffer_load_dwordx4 v4, s[8:11], s60 offen lds
    s_add_u32 s59, s59, 10240
    s_add_u32 s60, s60, 15360
    s_add_u32 m0, s65, 3072
    s_nop 0
    buffer_load_dwordx4 v3, s[4:7], s59 offen lds
    s_add_u32 m0, s65, 19456
    s_nop 0
    buffer_load_dwordx4 v4, s[8:11], s60 offen lds
    s_add_u32 s58, s58, 1
    s_cmp_eq_u32 s58, 10
    s_cselect_b32 s58, 0, s58
    s_add_u32 s65, s65, 32768
    s_and_b32 s65, s65, 131071
    s_add_u32 s66, s66, 1
    s_cmp_lt_u32 s66, 2
    s_cbranch_scc1 L_A_ld
    s_waitcnt vmcnt(8)
    s_barrier
    s_cmp_lt_u32 s66, 10
    s_cbranch_scc1 L_A_ld
    v_lshlrev_b32 v8, 4, v1
    s_cmp_ge_u32 s46, 6
    s_cselect_b32 s64, s57, s56
    s_cselect_b32 s60, 10, 11
    s_cselect_b32 s59, 32768, 0
    s_lshl_b32 s64, s64, s60
    s_add_u32 s64, s64, s59
    s_cmp_eq_u32 s46, 5
    s_cselect_b32 s60, 1024, 0
    s_add_u32 s64, s64, s60
    s_add_u32 s64, s64, 21004288
    buffer_load_dwordx4 v[16:19], v8, s[24:27], s64 offen sc1
    s_lshr_b32 s60, s60, 1
    s_add_u32 s60, s60, 123392
    s_cmp_ge_u32 s46, 6
    s_cselect_b32 s60, 122880, s60
    v_lshlrev_b32 v9, 3, v1
    v_add_u32 v9, s60, v9
    v_mov_b32 v12, 135168
    ds_read_b64 v[12:13], v12
    s_waitcnt lgkmcnt(0)
    v_readfirstlane_b32 s48, v12
    v_readfirstlane_b32 s49, v13
    s_waitcnt vmcnt(1)
    s_barrier
    s_waitcnt vmcnt(0)
    s_mov_b32 s94, 0
Lsp_1:
    v_cmp_ne_u64 vcc, s[48:49], v[18:19]
    s_cbranch_vccz Lspe_2
    s_add_u32 s94, s94, 1
    s_cmp_gt_u32 s94, 0x40000
    s_cbranch_scc1 Lspe_2
    buffer_load_dwordx4 v[16:19], v8, s[24:27], s64 offen sc1
    s_waitcnt vmcnt(0)
    s_branch Lsp_1
Lspe_2:
    ds_write_b64 v9, v[16:17]
    s_waitcnt lgkmcnt(0)
    s_barrier
L_A_w1:
    s_mov_b32 s47, 0
    s_branch L_A_done
L_A_idle_h:
    s_waitcnt lgkmcnt(0)
    v_lshrrev_b32 v4, 4, v1
    v_mul_u32_u24 v2, 3840, v4
    v_and_b32 v3, 15, v1
    v_lshl_add_u32 v2, v3, 4, v2
    s_sub_u32 s60, s46, 4
    s_mul_i32 s59, s60, 614400
    v_lshl_add_u32 v4, v3, 3, v4
    v_lshlrev_b32 v4, 2, v4
    s_lshl_b32 s60, s60, 9
    v_add_u32 v4, s60, v4
    s_min_u32 s60, s56, 14
    s_lshl_b32 s60, s60, 8
    s_add_u32 s59, s59, s60
    v_mov_b32 v16, 0
    v_mov_b32 v17, 0
    v_mov_b32 v18, 0
    v_mov_b32 v19, 0
    v_mov_b32 v20, 0
    v_mov_b32 v21, 0
    v_mov_b32 v22, 0
    v_mov_b32 v23, 0
    buffer_load_dwordx4 v[32:35], v2, s[8:11], s59 offen
    s_add_u32 s59, s59, 15360
    buffer_load_dwordx4 v[36:39], v2, s[8:11], s59 offen
    s_add_u32 s59, s59, 15360
    buffer_load_dwordx4 v[40:43], v2, s[8:11], s59 offen
    s_add_u32 s59, s59, 15360
    buffer_load_dwordx4 v[44:47], v2, s[8:11], s59 offen
    s_add_u32 s59, s59, 15360
    buffer_load_dwordx4 v[48:51], v2, s[8:11], s59 offen
    s_add_u32 s59, s59, 15360
    buffer_load_dwordx4 v[52:55], v2, s[8:11], s59 offen
    s_add_u32 s59, s59, 15360
    buffer_load_dwordx4 v[56:59], v2, s[8:11], s59 offen
    s_add_u32 s59, s59, 15360
    buffer_load_dwordx4 v[60:63], v2, s[8:11], s59 offen
    s_add_u32 s59, s59, 15360
    buffer_load_dwordx4 v[64:67], v2, s[8:11], s59 offen
    s_add_u32 s59, s59, 15360
    buffer_load_dwordx4 v[68:71], v2, s[8:11], s59 offen
    s_add_u32 s59, s59, 15360
    s_mov_b32 s60, 0
L_A_cs:
    s_waitcnt vmcnt(9)
    v_lshlrev_b32 v24, 16, v32
    v_and_b32 v25, 0xffff0000, v32
    v_pk_add_f32 v[16:17], v[16:17], v[24:25]
    v_lshlrev_b32 v26, 16, v33
    v_and_b32 v27, 0xffff0000, v33
    v_pk_add_f32 v[18:19], v[18:19], v[26:27]
    v_lshlrev_b32 v24, 16, v34
    v_and_b32 v25, 0xffff0000, v34
    v_pk_add_f32 v[20:21], v[20:21], v[24:25]
    v_lshlrev_b32 v26, 16, v35
    v_and_b32 v27, 0xffff0000, v35
    v_pk_add_f32 v[22:23], v[22:23], v[26:27]
    buffer_load_dwordx4 v[32:35], v2, s[8:11], s59 offen
    s_add_u32 s59, s59, 15360
    s_waitcnt vmcnt(9)
    v_lshlrev_b32 v24, 16, v36
    v_and_b32 v25, 0xffff0000, v36
    v_pk_add_f32 v[16:17], v[16:17], v[24:25]
    v_lshlrev_b32 v26, 16, v37
    v_and_b32 v27, 0xffff0000, v37
    v_pk_add_f32 v[18:19], v[18:19], v[26:27]
    v_lshlrev_b32 v24, 16, v38
    v_and_b32 v25, 0xffff0000, v38
    v_pk_add_f32 v[20:21], v[20:21], v[24:25]
    v_lshlrev_b32 v26, 16, v39
    v_and_b32 v27, 0xffff0000, v39
    v_pk_add_f32 v[22:23], v[22:23], v[26:27]
    buffer_load_dwordx4 v[36:39], v2, s[8:11], s59 offen
    s_add_u32 s59, s59, 15360
    s_waitcnt vmcnt(9)
    v_lshlrev_b32 v24, 16, v40
    v_and_b32 v25, 0xffff0000, v40
    v_pk_add_f32 v[16:17], v[16:17], v[24:25]
    v_lshlrev_b32 v26, 16, v41
    v_and_b32 v27, 0xffff0000, v41
    v_pk_add_f32 v[18:19], v[18:19], v[26:27]
    v_lshlrev_b32 v24, 16, v42
    v_and_b32 v25, 0xffff0000, v42
    v_pk_add_f32 v[20:21], v[20:21], v[24:25]
    v_lshlrev_b32 v26, 16, v43
    v_and_b32 v27, 0xffff0000, v43
    v_pk_add_f32 v[22:23], v[22:23], v[26:27]
    buffer_load_dwordx4 v[40:43], v2, s[8:11], s59 offen
    s_add_u32 s59, s59, 15360
    s_waitcnt vmcnt(9)
    v_lshlrev_b32 v24, 16, v44
    v_and_b32 v25, 0xffff0000, v44
    v_pk_add_f32 v[16:17], v[16:17], v[24:25]
    v_lshlrev_b32 v26, 16, v45
    v_and_b32 v27, 0xffff0000, v45
    v_pk_add_f32 v[18:19], v[18:19], v[26:27]
    v_lshlrev_b32 v24, 16, v46
    v_and_b32 v25, 0xffff0000, v46
    v_pk_add_f32 v[20:21], v[20:21], v[24:25]
    v_lshlrev_b32 v26, 16, v47
    v_and_b32 v27, 0xffff0000, v47
    v_pk_add_f32 v[22:23], v[22:23], v[26:27]
    buffer_load_dwordx4 v[44:47], v2, s[8:11], s59 offen
    s_add_u32 s59, s59, 15360
    s_waitcnt vmcnt(9)
    v_lshlrev_b32 v24, 16, v48
    v_and_b32 v25, 0xffff0000, v48
    v_pk_add_f32 v[16:17], v[16:17], v[24:25]
    v_lshlrev_b32 v26, 16, v49
    v_and_b32 v27, 0xffff0000, v49
    v_pk_add_f32 v[18:19], v[18:19], v[26:27]
    v_lshlrev_b32 v24, 16, v50
    v_and_b32 v25, 0xffff0000, v50
    v_pk_add_f32 v[20:21], v[20:21], v[24:25]
    v_lshlrev_b32 v26, 16, v51
    v_and_b32 v27, 0xffff0000, v51
    v_pk_add_f32 v[22:23], v[22:23], v[26:27]
    buffer_load_dwordx4 v[48:51], v2, s[8:11], s59 offen
    s_add_u32 s59, s59, 15360
    s_waitcnt vmcnt(9)
    v_lshlrev_b32 v24, 16, v52
    v_and_b32 v25, 0xffff0000, v52
    v_pk_add_f32 v[16:17], v[16:17], v[24:25]
    v_lshlrev_b32 v26, 16, v53
    v_and_b32 v27, 0xffff0000, v53
    v_pk_add_f32 v[18:19], v[18:19], v[26:27]
    v_lshlrev_b32 v24, 16, v54
    v_and_b32 v25, 0xffff0000, v54
    v_pk_add_f32 v[20:21], v[20:21], v[24:25]
    v_lshlrev_b32 v26, 16, v55
    v_and_b32 v27, 0xffff0000, v55
    v_pk_add_f32 v[22:23], v[22:23], v[26:27]
    buffer_load_dwordx4 v[52:55], v2, s[8:11], s59 offen
    s_add_u32 s59, s59, 15360
    s_waitcnt vmcnt(9)
    v_lshlrev_b32 v24, 16, v56
    v_and_b32 v25, 0xffff0000, v56
    v_pk_add_f32 v[16:17], v[16:17], v[24:25]
    v_lshlrev_b32 v26, 16, v57
    v_and_b32 v27, 0xffff0000, v57
    v_pk_add_f32 v[18:19], v[18:19], v[26:27]
    v_lshlrev_b32 v24, 16, v58
    v_and_b32 v25, 0xffff0000, v58
    v_pk_add_f32 v[20:21], v[20:21], v[24:25]
    v_lshlrev_b32 v26, 16, v59
    v_and_b32 v27, 0xffff0000, v59
    v_pk_add_f32 v[22:23], v[22:23], v[26:27]
    buffer_load_dwordx4 v[56:59], v2, s[8:11], s59 offen
    s_add_u32 s59, s59, 15360
    s_waitcnt vmcnt(9)
    v_lshlrev_b32 v24, 16, v60
    v_and_b32 v25, 0xffff0000, v60
    v_pk_add_f32 v[16:17], v[16:17], v[24:25]
    v_lshlrev_b32 v26, 16, v61
    v_and_b32 v27, 0xffff0000, v61
    v_pk_add_f32 v[18:19], v[18:19], v[26:27]
    v_lshlrev_b32 v24, 16, v62
    v_and_b32 v25, 0xffff0000, v62
    v_pk_add_f32 v[20:21], v[20:21], v[24:25]
    v_lshlrev_b32 v26, 16, v63
    v_and_b32 v27, 0xffff0000, v63
    v_pk_add_f32 v[22:23], v[22:23], v[26:27]
    buffer_load_dwordx4 v[60:63], v2, s[8:11], s59 offen
    s_add_u32 s59, s59, 15360
    s_waitcnt vmcnt(9)
    v_lshlrev_b32 v24, 16, v64
    v_and_b32 v25, 0xffff0000, v64
    v_pk_add_f32 v[16:17], v[16:17], v[24:25]
    v_lshlrev_b32 v26, 16, v65
    v_and_b32 v27, 0xffff0000, v65
    v_pk_add_f32 v[18:19], v[18:19], v[26:27]
    v_lshlrev_b32 v24, 16, v66
    v_and_b32 v25, 0xffff0000, v66
    v_pk_add_f32 v[20:21], v[20:21], v[24:25]
    v_lshlrev_b32 v26, 16, v67
    v_and_b32 v27, 0xffff0000, v67
    v_pk_add_f32 v[22:23], v[22:23], v[26:27]
    buffer_load_dwordx4 v[64:67], v2, s[8:11], s59 offen
    s_add_u32 s59, s59, 15360
    s_waitcnt vmcnt(9)
    v_lshlrev_b32 v24, 16, v68
    v_and_b32 v25, 0xffff0000, v68
    v_pk_add_f32 v[16:17], v[16:17], v[24:25]
    v_lshlrev_b32 v26, 16, v69
    v_and_b32 v27, 0xffff0000, v69
    v_pk_add_f32 v[18:19], v[18:19], v[26:27]
    v_lshlrev_b32 v24, 16, v70
    v_and_b32 v25, 0xffff0000, v70
    v_pk_add_f32 v[20:21], v[20:21], v[24:25]
    v_lshlrev_b32 v26, 16, v71
    v_and_b32 v27, 0xffff0000, v71
    v_pk_add_f32 v[22:23], v[22:23], v[26:27]
    buffer_load_dwordx4 v[68:71], v2, s[8:11], s59 offen
    s_add_u32 s59, s59, 15360
    s_add_u32 s60, s60, 1
    s_cmp_lt_u32 s60, 4
    s_cbranch_scc1 L_A_cs
    v_permlane16_swap_b32 v16, v17
    v_permlane16_swap_b32 v18, v19
    v_permlane16_swap_b32 v20, v21
    v_permlane16_swap_b32 v22, v23
    v_add_f32 v16, v16, v17
    v_add_f32 v18, v18, v19
    v_add_f32 v20, v20, v21
    v_add_f32 v22, v22, v23
    v_permlane32_swap_b32 v16, v18
    s_nop 0
    v_permlane32_swap_b32 v20, v22
    v_add_f32 v16, v16, v18
    v_add_f32 v20, v20, v22
    ds_write_b32 v4, v16
    ds_write_b32 v4, v20 offset:16
    s_waitcnt lgkmcnt(0)
    s_barrier
    v_mov_b32 v12, 135168
    ds_read_b64 v[12:13], v12
    s_waitcnt lgkmcnt(0)
    v_readfirstlane_b32 s48, v12
    v_readfirstlane_b32 s49, v13
    s_waitcnt vmcnt(0)
    s_cmp_lg_u32 s46, 4
    s_cbranch_scc1 L_A_w1
    s_cmp_eq_u32 s56, 15
    s_cbranch_scc1 L_A_w1
    v_lshlrev_b32 v4, 3, v1
    ds_read_b64 v[16:17], v4 offset:0
    ds_read_b64 v[20:21], v4 offset:512
    ds_read_b64 v[24:25], v4 offset:1024
    ds_read_b64 v[28:29], v4 offset:1536
    v_mov_b32 v18, s48
    v_mov_b32 v19, s49
    v_lshlrev_b32 v5, 4, v1
    s_lshl_b32 s59, s56, 10
    s_add_u32 s59, s59, 21037056
    s_waitcnt lgkmcnt(0)
    v_pk_add_f32 v[16:17], v[16:17], v[20:21]
    v_pk_add_f32 v[24:25], v[24:25], v[28:29]
    v_pk_add_f32 v[16:17], v[16:17], v[24:25]
    buffer_store_dwordx4 v[16:19], v5, s[24:27], s59 offen sc1
    s_branch L_A_w1
L_A_idle_c:
    s_waitcnt vmcnt(0)
    v_lshlrev_b32 v220, 16, v208
    v_and_b32 v221, 0xffff0000, v208
    v_lshlrev_b32 v222, 16, v209
    v_and_b32 v223, 0xffff0000, v209
    v_lshlrev_b32 v224, 16, v210
    v_and_b32 v225, 0xffff0000, v210
    v_lshlrev_b32 v226, 16, v211
    v_and_b32 v227, 0xffff0000, v211
    v_lshlrev_b32 v228, 16, v212
    v_and_b32 v229, 0xffff0000, v212
    v_lshlrev_b32 v230, 16, v213
    v_and_b32 v231, 0xffff0000, v213
    v_lshlrev_b32 v232, 16, v214
    v_and_b32 v233, 0xffff0000, v214
    v_lshlrev_b32 v234, 16, v215
    v_and_b32 v235, 0xffff0000, v215
    v_lshlrev_b32 v236, 16, v216
    v_and_b32 v237, 0xffff0000, v216
    v_lshlrev_b32 v238, 16, v217
    v_and_b32 v239, 0xffff0000, v217
    v_add_f32 v240, v220, v222
    v_add_f32 v241, v221, v223
    v_add_f32 v240, v240, v224
    v_add_f32 v241, v241, v225
    v_add_f32 v240, v240, v226
    v_add_f32 v241, v241, v227
    v_add_f32 v240, v240, v228
    v_add_f32 v241, v241, v229
    v_add_f32 v240, v240, v230
    v_add_f32 v241, v241, v231
    v_add_f32 v240, v240, v232
    v_add_f32 v241, v241, v233
    v_add_f32 v240, v240, v234
    v_add_f32 v241, v241, v235
    v_add_f32 v240, v240, v236
    v_add_f32 v241, v241, v237
    v_add_f32 v240, v240, v238
    v_add_f32 v241, v241, v239
    v_add_f32 v240, v240, v241
    s_nop 1
    v_add_f32_dpp v240, v240, v240 quad_perm:[1,0,3,2] row_mask:0xf bank_mask:0xf
    s_nop 1
    v_add_f32_dpp v240, v240, v240 quad_perm:[2,3,0,1] row_mask:0xf bank_mask:0xf
    s_nop 1
    v_add_f32_dpp v240, v240, v240 row_half_mirror row_mask:0xf bank_mask:0xf
    s_nop 1
    v_add_f32_dpp v240, v240, v240 row_mirror row_mask:0xf bank_mask:0xf
    v_mov_b32 v241, v240
    s_nop 1
    v_permlane16_swap_b32 v240, v241
    v_add_f32 v240, v240, v241
    v_mul_f32 v248, 0x3acccccd, v240
    v_sub_f32 v220, v220, v248
    v_sub_f32 v221, v221, v248
    v_sub_f32 v222, v222, v248
    v_sub_f32 v223, v223, v248
    v_sub_f32 v224, v224, v248
    v_sub_f32 v225, v225, v248
    v_sub_f32 v226, v226, v248
    v_sub_f32 v227, v227, v248
    v_sub_f32 v228, v228, v248
    v_sub_f32 v229, v229, v248
    v_sub_f32 v230, v230, v248
    v_sub_f32 v231, v231, v248
    v_sub_f32 v232, v232, v248
    v_sub_f32 v233, v233, v248
    v_sub_f32 v234, v234, v248
    v_sub_f32 v235, v235, v248
    v_sub_f32 v236, v236, v248
    v_sub_f32 v237, v237, v248
    v_sub_f32 v238, v238, v248
    v_sub_f32 v239, v239, v248
    v_mov_b32 v246, 0
    buffer_load_dwordx2 v[250:251], v246, s[32:35], 0 offen sc1
    v_mul_f32 v240, v220, v220
    v_mul_f32 v241, v221, v221
    v_fmac_f32 v240, v222, v222
    v_fmac_f32 v241, v223, v223
    v_fmac_f32 v240, v224, v224
    v_fmac_f32 v241, v225, v225
    v_fmac_f32 v240, v226, v226
    v_fmac_f32 v241, v227, v227
    v_fmac_f32 v240, v228, v228
    v_fmac_f32 v241, v229, v229
    v_fmac_f32 v240, v230, v230
    v_fmac_f32 v241, v231, v231
    v_fmac_f32 v240, v232, v232
    v_fmac_f32 v241, v233, v233
    v_fmac_f32 v240, v234, v234
    v_fmac_f32 v241, v235, v235
    v_fmac_f32 v240, v236, v236
    v_fmac_f32 v241, v237, v237
    v_fmac_f32 v240, v238, v238
    v_fmac_f32 v241, v239, v239
    v_add_f32 v240, v240, v241
    s_nop 1
    v_add_f32_dpp v240, v240, v240 quad_perm:[1,0,3,2] row_mask:0xf bank_mask:0xf
    s_nop 1
    v_add_f32_dpp v240, v240, v240 quad_perm:[2,3,0,1] row_mask:0xf bank_mask:0xf
    s_nop 1
    v_add_f32_dpp v240, v240, v240 row_half_mirror row_mask:0xf bank_mask:0xf
    s_nop 1
    v_add_f32_dpp v240, v240, v240 row_mirror row_mask:0xf bank_mask:0xf
    v_mov_b32 v241, v240
    s_nop 1
    v_permlane16_swap_b32 v240, v241
    v_add_f32 v240, v240, v241
    v_mov_b32 v241, 0x3727c5ac
    v_fmac_f32 v241, 0x3acccccd, v240
    v_rsq_f32 v249, v241
    v_lshrrev_b32 v240, 1, v1
    v_and_b32 v240, 16, v240
    v_mov_b32 v241, 135168
    s_lshl_b32 s52, s52, 4
    s_add_u32 s52, s52, 21004288
    s_mov_b32 s94, 0
Lnon_4:
    s_waitcnt vmcnt(0)
    v_cmp_eq_u32 vcc, 0, v250
    s_cbranch_vccnz Lnon_4_again
Lnone_5:
    buffer_store_dwordx4 v[248:251], v240, s[24:27], s52 offen sc1
    ds_write_b64 v241, v[250:251]
    v_readfirstlane_b32 s48, v250
    v_readfirstlane_b32 s49, v251
    s_waitcnt lgkmcnt(0)
    s_barrier
    s_branch L_A_w1
L_A_comp:
    s_lshl_b32 s52, s44, 5
    s_add_u32 s52, s52, s45
    s_lshl_b32 s52, s52, 2
    s_add_u32 s52, s52, s46
    s_lshl_b32 s52, s52, 1
    s_mul_i32 s53, s52, 1280
    v_lshrrev_b32 v240, 5, v1
    v_mul_u32_u24 v240, 1280, v240
    v_and_b32 v241, 31, v1
    v_lshl_add_u32 v242, v241, 4, v240
    v_lshl_add_u32 v243, v241, 3, v240
    s_waitcnt lgkmcnt(0)
    s_or_b32 s54, s2, s46
    s_cmp_lg_u32 s54, 0
    s_cbranch_scc1 Lnn_6
    s_memrealtime s[48:49]
    s_waitcnt lgkmcnt(0)
    s_or_b32 s48, s48, 1
    s_or_b32 s49, s49, 0x80000000
    v_mov_b32 v250, s48
    v_mov_b32 v251, s49
    v_mov_b32 v246, 0
    s_mov_b64 exec, 1
    buffer_store_dwordx2 v[250:251], v246, s[32:35], 0 offen sc1
    s_mov_b64 exec, -1
Lnn_6:
    buffer_load_dwordx4 v[208:211], v242, s[4:7], s53 offen
    buffer_load_dwordx4 v[212:215], v242, s[4:7], s53 offen offset:512
    buffer_load_dwordx2 v[216:217], v243, s[4:7], s53 offen offset:1024
    s_cmp_eq_u32 s57, 15
    s_cbranch_scc1 L_A_idle_c
    s_lshr_b32 s59, s46, 1
    s_lshl_b32 s59, s59, 13
    v_and_b32 v80, 31, v1
    v_lshrrev_b32 v81, 5, v1
    v_lshlrev_b32 v82, 7, v80
    v_add_u32 v82, s59, v82
    v_bfe_u32 v83, v80, 1, 3
    v_xor_b32 v83, v83, v81
    v_xor_b32 v80, 0, v83
    v_lshl_add_u32 v6, v80, 4, v82
    v_add_u32 v10, 0x10000, v6
    v_xor_b32 v80, 2, v83
    v_lshl_add_u32 v7, v80, 4, v82
    v_add_u32 v11, 0x10000, v7
    v_xor_b32 v80, 4, v83
    v_lshl_add_u32 v8, v80, 4, v82
    v_add_u32 v12, 0x10000, v8
    v_xor_b32 v80, 6, v83
    v_lshl_add_u32 v9, v80, 4, v82
    v_add_u32 v13, 0x10000, v9
    v_bfe_u32 v80, v1, 2, 2
    v_lshl_add_u32 v82, v81, 3, v80
    v_lshlrev_b32 v82, 8, v82
    v_and_b32 v83, 1, v1
    v_lshl_add_u32 v82, v83, 3, v82
    v_add_u32 v82, 16384, v82
    v_bfe_u32 v81, v1, 4, 1
    v_bfe_u32 v83, v1, 1, 1
    v_lshl_add_u32 v81, v81, 1, v83
    v_lshl_add_u32 v81, v80, 2, v81
    s_and_b32 s59, s46, 1
    s_lshl_b32 s59, s59, 3
    s_add_u32 s60, s59, 0
    v_xor_b32 v80, s60, v81
    v_lshl_add_u32 v2, v80, 4, v82
    v_add_u32 v4, 0x10000, v2
    s_add_u32 s60, s59, 4
    v_xor_b32 v80, s60, v81
    v_lshl_add_u32 v3, v80, 4, v82
    v_add_u32 v5, 0x10000, v3
    v_lshrrev_b32 v185, 5, v1
    v_lshlrev_b32 v180, 4, v185
    s_and_b32 s59, s46, 1
    s_lshl_b32 s59, s59, 8
    s_add_u32 s59, s59, 122880
    v_add_u32 v180, s59, v180
    v_and_b32 v182, 31, v1
    v_lshlrev_b32 v184, 4, v182
    v_mul_u32_u24 v186, 16640, v185
    v_add_u32 v184, v184, v186
    v_lshlrev_b32 v182, 3, v182
    s_lshr_b32 s60, s46, 1
    s_lshl_b32 s60, s60, 9
    s_add_u32 s59, s60, 123392
    v_add_u32 v181, s59, v182
    v_lshl_add_u32 v182, v185, 9, v182
    s_lshl_b32 s59, s46, 13
    s_add_u32 s59, s59, 131072
    v_add_u32 v182, s59, v182
    v_lshlrev_b32 v183, 4, v1
    v_add_u32 v183, s59, v183
    s_lshl_b32 s61, s57, 1
    s_and_b32 s59, s46, 1
    s_add_u32 s61, s61, s59
    s_mul_i32 s61, s61, 266240
    s_lshl_b32 s59, s56, 10
    s_add_u32 s61, s61, s59
    s_add_u32 s61, s61, s60
    s_cmp_lt_u32 s57, 5
    s_cselect_b32 s62, 0x3ea52b5c, 1.0
    s_barrier
    ds_read_b64_tr_b16 v[80:81], v2 offset:0
    ds_read_b64_tr_b16 v[82:83], v2 offset:1024
    ds_read_b64_tr_b16 v[96:97], v3 offset:0
    ds_read_b64_tr_b16 v[98:99], v3 offset:1024
    ds_read_b128 v[112:115], v6 offset:0
    ds_read_b128 v[128:131], v6 offset:4096
    ds_read_b64_tr_b16 v[84:85], v2 offset:4096
    ds_read_b64_tr_b16 v[86:87], v2 offset:5120
    ds_read_b64_tr_b16 v[100:101], v3 offset:4096
    ds_read_b64_tr_b16 v[102:103], v3 offset:5120
    ds_read_b128 v[116:119], v7 offset:0
    ds_read_b128 v[132:135], v7 offset:4096
    s_waitcnt lgkmcnt(0)
    ds_read_b64_tr_b16 v[88:89], v2 offset:8192
    ds_read_b64_tr_b16 v[90:91], v2 offset:9216
    v_mfma_f32_32x32x16_bf16 v[16:31], v[80:83], v[112:115], 0
    ds_read_b64_tr_b16 v[104:105], v3 offset:8192
    ds_read_b64_tr_b16 v[106:107], v3 offset:9216
    v_mfma_f32_32x32x16_bf16 v[32:47], v[80:83], v[128:131], 0
    ds_read_b128 v[120:123], v8 offset:0
    ds_read_b128 v[136:139], v8 offset:4096
    v_mfma_f32_32x32x16_bf16 v[48:63], v[96:99], v[112:115], 0
    ds_read_b64_tr_b16 v[92:93], v2 offset:12288
    ds_read_b64_tr_b16 v[94:95], v2 offset:13312
    v_mfma_f32_32x32x16_bf16 v[64:79], v[96:99], v[128:131], 0
    ds_read_b64_tr_b16 v[108:109], v3 offset:12288
    ds_read_b64_tr_b16 v[110:111], v3 offset:13312
    v_mfma_f32_32x32x16_bf16 v[16:31], v[84:87], v[116:119], v[16:31]
    ds_read_b128 v[124:127], v9 offset:0
    ds_read_b128 v[140:143], v9 offset:4096
    v_mfma_f32_32x32x16_bf16 v[32:47], v[84:87], v[132:135], v[32:47]
    v_mfma_f32_32x32x16_bf16 v[48:63], v[100:103], v[116:119], v[48:63]
    v_mfma_f32_32x32x16_bf16 v[64:79], v[100:103], v[132:135], v[64:79]
    s_waitcnt lgkmcnt(0)
    s_barrier
    ds_read_b64_tr_b16 v[80:81], v2 offset:32768
    ds_read_b64_tr_b16 v[82:83], v2 offset:33792
    v_mfma_f32_32x32x16_bf16 v[16:31], v[88:91], v[120:123], v[16:31]
    s_waitcnt vmcnt(0)
    v_lshlrev_b32 v220, 16, v208
    ds_read_b64_tr_b16 v[96:97], v3 offset:32768
    ds_read_b64_tr_b16 v[98:99], v3 offset:33792
    v_mfma_f32_32x32x16_bf16 v[32:47], v[88:91], v[136:139], v[32:47]
    v_and_b32 v221, 0xffff0000, v208
    v_lshlrev_b32 v222, 16, v209
    ds_read_b128 v[112:115], v6 offset:32768
    ds_read_b128 v[128:131], v6 offset:36864
    v_mfma_f32_32x32x16_bf16 v[48:63], v[104:107], v[120:123], v[48:63]
    v_and_b32 v223, 0xffff0000, v209
    v_lshlrev_b32 v224, 16, v210
    ds_read_b64_tr_b16 v[84:85], v2 offset:36864
    ds_read_b64_tr_b16 v[86:87], v2 offset:37888
    v_mfma_f32_32x32x16_bf16 v[64:79], v[104:107], v[136:139], v[64:79]
    v_and_b32 v225, 0xffff0000, v210
    v_lshlrev_b32 v226, 16, v211
    ds_read_b64_tr_b16 v[100:101], v3 offset:36864
    ds_read_b64_tr_b16 v[102:103], v3 offset:37888
    v_mfma_f32_32x32x16_bf16 v[16:31], v[92:95], v[124:127], v[16:31]
    v_and_b32 v227, 0xffff0000, v211
    v_lshlrev_b32 v228, 16, v212
    ds_read_b128 v[116:119], v7 offset:32768
    ds_read_b128 v[132:135], v7 offset:36864
    v_mfma_f32_32x32x16_bf16 v[32:47], v[92:95], v[140:143], v[32:47]
    v_and_b32 v229, 0xffff0000, v212
    v_lshlrev_b32 v230, 16, v213
    v_mfma_f32_32x32x16_bf16 v[48:63], v[108:111], v[124:127], v[48:63]
    v_and_b32 v231, 0xffff0000, v213
    v_lshlrev_b32 v232, 16, v214
    v_and_b32 v233, 0xffff0000, v214
    v_lshlrev_b32 v234, 16, v215
    v_mfma_f32_32x32x16_bf16 v[64:79], v[108:111], v[140:143], v[64:79]
    v_and_b32 v235, 0xffff0000, v215
    v_lshlrev_b32 v236, 16, v216
    v_and_b32 v237, 0xffff0000, v216
    v_lshlrev_b32 v238, 16, v217
    s_waitcnt lgkmcnt(0)
    ds_read_b64_tr_b16 v[88:89], v2 offset:40960
    ds_read_b64_tr_b16 v[90:91], v2 offset:41984
    v_mfma_f32_32x32x16_bf16 v[16:31], v[80:83], v[112:115], v[16:31]
    v_and_b32 v239, 0xffff0000, v217
    v_add_f32 v240, v220, v222
    ds_read_b64_tr_b16 v[104:105], v3 offset:40960
    ds_read_b64_tr_b16 v[106:107], v3 offset:41984
    v_mfma_f32_32x32x16_bf16 v[32:47], v[80:83], v[128:131], v[32:47]
    v_add_f32 v241, v221, v223
    v_add_f32 v240, v240, v224
    ds_read_b128 v[120:123], v8 offset:32768
    ds_read_b128 v[136:139], v8 offset:36864
    v_mfma_f32_32x32x16_bf16 v[48:63], v[96:99], v[112:115], v[48:63]
    v_add_f32 v241, v241, v225
    v_add_f32 v240, v240, v226
    ds_read_b64_tr_b16 v[92:93], v2 offset:45056
    ds_read_b64_tr_b16 v[94:95], v2 offset:46080
    v_mfma_f32_32x32x16_bf16 v[64:79], v[96:99], v[128:131], v[64:79]
    v_add_f32 v241, v241, v227
    v_add_f32 v240, v240, v228
    ds_read_b64_tr_b16 v[108:109], v3 offset:45056
    ds_read_b64_tr_b16 v[110:111], v3 offset:46080
    v_mfma_f32_32x32x16_bf16 v[16:31], v[84:87], v[116:119], v[16:31]
    v_add_f32 v241, v241, v229
    v_add_f32 v240, v240, v230
    ds_read_b128 v[124:127], v9 offset:32768
    ds_read_b128 v[140:143], v9 offset:36864
    v_mfma_f32_32x32x16_bf16 v[32:47], v[84:87], v[132:135], v[32:47]
    v_add_f32 v241, v241, v231
    v_add_f32 v240, v240, v232
    v_mfma_f32_32x32x16_bf16 v[48:63], v[100:103], v[116:119], v[48:63]
    v_add_f32 v241, v241, v233
    v_add_f32 v240, v240, v234
    v_add_f32 v241, v241, v235
    v_add_f32 v240, v240, v236
    v_mfma_f32_32x32x16_bf16 v[64:79], v[100:103], v[132:135], v[64:79]
    v_add_f32 v241, v241, v237
    v_add_f32 v240, v240, v238
    v_add_f32 v241, v241, v239
    v_add_f32 v240, v240, v241
    s_waitcnt lgkmcnt(0)
    s_barrier
    ds_read_b64_tr_b16 v[80:81], v4 offset:0
    ds_read_b64_tr_b16 v[82:83], v4 offset:1024
    v_mfma_f32_32x32x16_bf16 v[16:31], v[88:91], v[120:123], v[16:31]
    v_add_f32_dpp v240, v240, v240 quad_perm:[1,0,3,2] row_mask:0xf bank_mask:0xf
    s_nop 1
    v_add_f32_dpp v240, v240, v240 quad_perm:[2,3,0,1] row_mask:0xf bank_mask:0xf
    ds_read_b64_tr_b16 v[96:97], v5 offset:0
    ds_read_b64_tr_b16 v[98:99], v5 offset:1024
    v_mfma_f32_32x32x16_bf16 v[32:47], v[88:91], v[136:139], v[32:47]
    v_add_f32_dpp v240, v240, v240 row_half_mirror row_mask:0xf bank_mask:0xf
    s_nop 1
    v_add_f32_dpp v240, v240, v240 row_mirror row_mask:0xf bank_mask:0xf
    ds_read_b128 v[112:115], v10 offset:0
    ds_read_b128 v[128:131], v10 offset:4096
    v_mfma_f32_32x32x16_bf16 v[48:63], v[104:107], v[120:123], v[48:63]
    v_mov_b32 v241, v240
    s_nop 1
    v_permlane16_swap_b32 v240, v241
    ds_read_b64_tr_b16 v[84:85], v4 offset:4096
    ds_read_b64_tr_b16 v[86:87], v4 offset:5120
    v_mfma_f32_32x32x16_bf16 v[64:79], v[104:107], v[136:139], v[64:79]
    v_add_f32 v240, v240, v241
    v_mul_f32 v248, 0x3acccccd, v240
    ds_read_b64_tr_b16 v[100:101], v5 offset:4096
    ds_read_b64_tr_b16 v[102:103], v5 offset:5120
    v_mfma_f32_32x32x16_bf16 v[16:31], v[92:95], v[124:127], v[16:31]
    v_sub_f32 v220, v220, v248
    v_sub_f32 v221, v221, v248
    ds_read_b128 v[116:119], v11 offset:0
    ds_read_b128 v[132:135], v11 offset:4096
    v_mfma_f32_32x32x16_bf16 v[32:47], v[92:95], v[140:143], v[32:47]
    v_sub_f32 v222, v222, v248
    v_sub_f32 v223, v223, v248
    v_mfma_f32_32x32x16_bf16 v[48:63], v[108:111], v[124:127], v[48:63]
    v_sub_f32 v224, v224, v248
    v_sub_f32 v225, v225, v248
    v_sub_f32 v226, v226, v248
    v_sub_f32 v227, v227, v248
    v_mfma_f32_32x32x16_bf16 v[64:79], v[108:111], v[140:143], v[64:79]
    v_sub_f32 v228, v228, v248
    v_sub_f32 v229, v229, v248
    v_sub_f32 v230, v230, v248
    v_sub_f32 v231, v231, v248
    s_waitcnt lgkmcnt(0)
    ds_read_b64_tr_b16 v[88:89], v4 offset:8192
    ds_read_b64_tr_b16 v[90:91], v4 offset:9216
    v_mfma_f32_32x32x16_bf16 v[16:31], v[80:83], v[112:115], v[16:31]
    v_sub_f32 v232, v232, v248
    v_sub_f32 v233, v233, v248
    ds_read_b64_tr_b16 v[104:105], v5 offset:8192
    ds_read_b64_tr_b16 v[106:107], v5 offset:9216
    v_mfma_f32_32x32x16_bf16 v[32:47], v[80:83], v[128:131], v[32:47]
    v_sub_f32 v234, v234, v248
    v_sub_f32 v235, v235, v248
    ds_read_b128 v[120:123], v12 offset:0
    ds_read_b128 v[136:139], v12 offset:4096
    v_mfma_f32_32x32x16_bf16 v[48:63], v[96:99], v[112:115], v[48:63]
    v_sub_f32 v236, v236, v248
    v_sub_f32 v237, v237, v248
    ds_read_b64_tr_b16 v[92:93], v4 offset:12288
    ds_read_b64_tr_b16 v[94:95], v4 offset:13312
    v_mfma_f32_32x32x16_bf16 v[64:79], v[96:99], v[128:131], v[64:79]
    v_sub_f32 v238, v238, v248
    v_sub_f32 v239, v239, v248
    ds_read_b64_tr_b16 v[108:109], v5 offset:12288
    ds_read_b64_tr_b16 v[110:111], v5 offset:13312
    v_mfma_f32_32x32x16_bf16 v[16:31], v[84:87], v[116:119], v[16:31]
    v_mov_b32 v246, 0
    buffer_load_dwordx2 v[250:251], v246, s[32:35], 0 offen sc1
    ds_read_b128 v[124:127], v13 offset:0
    ds_read_b128 v[140:143], v13 offset:4096
    v_mfma_f32_32x32x16_bf16 v[32:47], v[84:87], v[132:135], v[32:47]
    v_mul_f32 v240, v220, v220
    v_mul_f32 v241, v221, v221
    v_mfma_f32_32x32x16_bf16 v[48:63], v[100:103], v[116:119], v[48:63]
    v_fmac_f32 v240, v222, v222
    v_fmac_f32 v241, v223, v223
    v_fmac_f32 v240, v224, v224
    v_fmac_f32 v241, v225, v225
    v_mfma_f32_32x32x16_bf16 v[64:79], v[100:103], v[132:135], v[64:79]
    v_fmac_f32 v240, v226, v226
    v_fmac_f32 v241, v227, v227
    v_fmac_f32 v240, v228, v228
    v_fmac_f32 v241, v229, v229
    s_waitcnt lgkmcnt(0)
    s_barrier
    ds_read_b64_tr_b16 v[80:81], v4 offset:32768
    ds_read_b64_tr_b16 v[82:83], v4 offset:33792
    v_mfma_f32_32x32x16_bf16 v[16:31], v[88:91], v[120:123], v[16:31]
    v_fmac_f32 v240, v230, v230
    v_fmac_f32 v241, v231, v231
    ds_read_b64_tr_b16 v[96:97], v5 offset:32768
    ds_read_b64_tr_b16 v[98:99], v5 offset:33792
    v_mfma_f32_32x32x16_bf16 v[32:47], v[88:91], v[136:139], v[32:47]
    v_fmac_f32 v240, v232, v232
    v_fmac_f32 v241, v233, v233
    ds_read_b128 v[112:115], v10 offset:32768
    ds_read_b128 v[128:131], v10 offset:36864
    v_mfma_f32_32x32x16_bf16 v[48:63], v[104:107], v[120:123], v[48:63]
    v_fmac_f32 v240, v234, v234
    v_fmac_f32 v241, v235, v235
    ds_read_b64_tr_b16 v[84:85], v4 offset:36864
    ds_read_b64_tr_b16 v[86:87], v4 offset:37888
    v_mfma_f32_32x32x16_bf16 v[64:79], v[104:107], v[136:139], v[64:79]
    v_fmac_f32 v240, v236, v236
    v_fmac_f32 v241, v237, v237
    ds_read_b64_tr_b16 v[100:101], v5 offset:36864
    ds_read_b64_tr_b16 v[102:103], v5 offset:37888
    v_mfma_f32_32x32x16_bf16 v[16:31], v[92:95], v[124:127], v[16:31]
    v_fmac_f32 v240, v238, v238
    v_fmac_f32 v241, v239, v239
    ds_read_b128 v[116:119], v11 offset:32768
    ds_read_b128 v[132:135], v11 offset:36864
    v_mfma_f32_32x32x16_bf16 v[32:47], v[92:95], v[140:143], v[32:47]
    v_add_f32 v240, v240, v241
    s_nop 1
    v_add_f32_dpp v240, v240, v240 quad_perm:[1,0,3,2] row_mask:0xf bank_mask:0xf
    v_mfma_f32_32x32x16_bf16 v[48:63], v[108:111], v[124:127], v[48:63]
    s_nop 0
    v_add_f32_dpp v240, v240, v240 quad_perm:[2,3,0,1] row_mask:0xf bank_mask:0xf
    s_nop 1
    v_add_f32_dpp v240, v240, v240 row_half_mirror row_mask:0xf bank_mask:0xf
    s_nop 1
    v_add_f32_dpp v240, v240, v240 row_mirror row_mask:0xf bank_mask:0xf
    v_mov_b32 v241, v240
    v_mfma_f32_32x32x16_bf16 v[64:79], v[108:111], v[140:143], v[64:79]
    s_nop 0
    v_permlane16_swap_b32 v240, v241
    v_add_f32 v240, v240, v241
    v_mov_b32 v241, 0x3727c5ac
    v_fmac_f32 v241, 0x3acccccd, v240
    s_waitcnt lgkmcnt(0)
    ds_read_b64_tr_b16 v[88:89], v4 offset:40960
    ds_read_b64_tr_b16 v[90:91], v4 offset:41984
    v_mfma_f32_32x32x16_bf16 v[16:31], v[80:83], v[112:115], v[16:31]
    v_rsq_f32 v249, v241
    v_lshrrev_b32 v240, 1, v1
    ds_read_b64_tr_b16 v[104:105], v5 offset:40960
    ds_read_b64_tr_b16 v[106:107], v5 offset:41984
    v_mfma_f32_32x32x16_bf16 v[32:47], v[80:83], v[128:131], v[32:47]
    v_and_b32 v240, 16, v240
    v_mov_b32 v241, 135168
    ds_read_b128 v[120:123], v12 offset:32768
    ds_read_b128 v[136:139], v12 offset:36864
    v_mfma_f32_32x32x16_bf16 v[48:63], v[96:99], v[112:115], v[48:63]
    s_lshl_b32 s52, s52, 4
    s_add_u32 s52, s52, 21004288
    ds_read_b64_tr_b16 v[92:93], v4 offset:45056
    ds_read_b64_tr_b16 v[94:95], v4 offset:46080
    v_mfma_f32_32x32x16_bf16 v[64:79], v[96:99], v[128:131], v[64:79]
    s_mov_b32 s94, 0
    ds_read_b64_tr_b16 v[108:109], v5 offset:45056
    ds_read_b64_tr_b16 v[110:111], v5 offset:46080
    v_mfma_f32_32x32x16_bf16 v[16:31], v[84:87], v[116:119], v[16:31]
    ds_read_b128 v[124:127], v13 offset:32768
    ds_read_b128 v[140:143], v13 offset:36864
    v_mfma_f32_32x32x16_bf16 v[32:47], v[84:87], v[132:135], v[32:47]
    v_mfma_f32_32x32x16_bf16 v[48:63], v[100:103], v[116:119], v[48:63]
    v_mfma_f32_32x32x16_bf16 v[64:79], v[100:103], v[132:135], v[64:79]
    s_waitcnt lgkmcnt(0)
    s_barrier
    ds_read_b64_tr_b16 v[80:81], v2 offset:0
    ds_read_b64_tr_b16 v[82:83], v2 offset:1024
    v_mfma_f32_32x32x16_bf16 v[16:31], v[88:91], v[120:123], v[16:31]
    ds_read_b64_tr_b16 v[96:97], v3 offset:0
    ds_read_b64_tr_b16 v[98:99], v3 offset:1024
    v_mfma_f32_32x32x16_bf16 v[32:47], v[88:91], v[136:139], v[32:47]
    ds_read_b128 v[112:115], v6 offset:0
    ds_read_b128 v[128:131], v6 offset:4096
    v_mfma_f32_32x32x16_bf16 v[48:63], v[104:107], v[120:123], v[48:63]
    ds_read_b64_tr_b16 v[84:85], v2 offset:4096
    ds_read_b64_tr_b16 v[86:87], v2 offset:5120
    v_mfma_f32_32x32x16_bf16 v[64:79], v[104:107], v[136:139], v[64:79]
    ds_read_b64_tr_b16 v[100:101], v3 offset:4096
    ds_read_b64_tr_b16 v[102:103], v3 offset:5120
    v_mfma_f32_32x32x16_bf16 v[16:31], v[92:95], v[124:127], v[16:31]
    ds_read_b128 v[116:119], v7 offset:0
    ds_read_b128 v[132:135], v7 offset:4096
    v_mfma_f32_32x32x16_bf16 v[32:47], v[92:95], v[140:143], v[32:47]
    v_mfma_f32_32x32x16_bf16 v[48:63], v[108:111], v[124:127], v[48:63]
    v_mfma_f32_32x32x16_bf16 v[64:79], v[108:111], v[140:143], v[64:79]
Lnon_7:
    s_waitcnt vmcnt(0)
    v_cmp_eq_u32 vcc, 0, v250
    s_cbranch_vccnz Lnon_7_again
Lnone_8:
    s_waitcnt lgkmcnt(0)
    ds_read_b64_tr_b16 v[88:89], v2 offset:8192
    ds_read_b64_tr_b16 v[90:91], v2 offset:9216
    v_mfma_f32_32x32x16_bf16 v[16:31], v[80:83], v[112:115], v[16:31]
    ds_read_b64_tr_b16 v[104:105], v3 offset:8192
    ds_read_b64_tr_b16 v[106:107], v3 offset:9216
    v_mfma_f32_32x32x16_bf16 v[32:47], v[80:83], v[128:131], v[32:47]
    ds_read_b128 v[120:123], v8 offset:0
    ds_read_b128 v[136:139], v8 offset:4096
    v_mfma_f32_32x32x16_bf16 v[48:63], v[96:99], v[112:115], v[48:63]
    ds_read_b64_tr_b16 v[92:93], v2 offset:12288
    ds_read_b64_tr_b16 v[94:95], v2 offset:13312
    v_mfma_f32_32x32x16_bf16 v[64:79], v[96:99], v[128:131], v[64:79]
    ds_read_b64_tr_b16 v[108:109], v3 offset:12288
    ds_read_b64_tr_b16 v[110:111], v3 offset:13312
    v_mfma_f32_32x32x16_bf16 v[16:31], v[84:87], v[116:119], v[16:31]
    ds_read_b128 v[124:127], v9 offset:0
    ds_read_b128 v[140:143], v9 offset:4096
    v_mfma_f32_32x32x16_bf16 v[32:47], v[84:87], v[132:135], v[32:47]
    v_mfma_f32_32x32x16_bf16 v[48:63], v[100:103], v[116:119], v[48:63]
    v_mfma_f32_32x32x16_bf16 v[64:79], v[100:103], v[132:135], v[64:79]
    buffer_store_dwordx4 v[248:251], v240, s[24:27], s52 offen sc1
    ds_write_b64 v241, v[250:251]
    s_waitcnt lgkmcnt(0)
    s_barrier
    ds_read_b64_tr_b16 v[80:81], v2 offset:32768
    ds_read_b64_tr_b16 v[82:83], v2 offset:33792
    v_mfma_f32_32x32x16_bf16 v[16:31], v[88:91], v[120:123], v[16:31]
    ds_read_b64_tr_b16 v[96:97], v3 offset:32768
    ds_read_b64_tr_b16 v[98:99], v3 offset:33792
    v_mfma_f32_32x32x16_bf16 v[32:47], v[88:91], v[136:139], v[32:47]
    ds_read_b128 v[112:115], v6 offset:32768
    ds_read_b128 v[128:131], v6 offset:36864
    v_mfma_f32_32x32x16_bf16 v[48:63], v[104:107], v[120:123], v[48:63]
    ds_read_b64_tr_b16 v[84:85], v2 offset:36864
    ds_read_b64_tr_b16 v[86:87], v2 offset:37888
    v_mfma_f32_32x32x16_bf16 v[64:79], v[104:107], v[136:139], v[64:79]
    ds_read_b64_tr_b16 v[100:101], v3 offset:36864
    ds_read_b64_tr_b16 v[102:103], v3 offset:37888
    v_mfma_f32_32x32x16_bf16 v[16:31], v[92:95], v[124:127], v[16:31]
    ds_read_b128 v[116:119], v7 offset:32768
    ds_read_b128 v[132:135], v7 offset:36864
    v_mfma_f32_32x32x16_bf16 v[32:47], v[92:95], v[140:143], v[32:47]
    v_mfma_f32_32x32x16_bf16 v[48:63], v[108:111], v[124:127], v[48:63]
    v_mfma_f32_32x32x16_bf16 v[64:79], v[108:111], v[140:143], v[64:79]
    s_waitcnt lgkmcnt(0)
    ds_read_b64_tr_b16 v[88:89], v2 offset:40960
    ds_read_b64_tr_b16 v[90:91], v2 offset:41984
    v_mfma_f32_32x32x16_bf16 v[16:31], v[80:83], v[112:115], v[16:31]
    ds_read_b64_tr_b16 v[104:105], v3 offset:40960
    ds_read_b64_tr_b16 v[106:107], v3 offset:41984
    v_mfma_f32_32x32x16_bf16 v[32:47], v[80:83], v[128:131], v[32:47]
    ds_read_b128 v[120:123], v8 offset:32768
    ds_read_b128 v[136:139], v8 offset:36864
    v_mfma_f32_32x32x16_bf16 v[48:63], v[96:99], v[112:115], v[48:63]
    ds_read_b64_tr_b16 v[92:93], v2 offset:45056
    ds_read_b64_tr_b16 v[94:95], v2 offset:46080
    v_mfma_f32_32x32x16_bf16 v[64:79], v[96:99], v[128:131], v[64:79]
    ds_read_b64_tr_b16 v[108:109], v3 offset:45056
    ds_read_b64_tr_b16 v[110:111], v3 offset:46080
    v_mfma_f32_32x32x16_bf16 v[16:31], v[84:87], v[116:119], v[16:31]
    ds_read_b128 v[124:127], v9 offset:32768
    ds_read_b128 v[140:143], v9 offset:36864
    v_mfma_f32_32x32x16_bf16 v[32:47], v[84:87], v[132:135], v[32:47]
    v_mfma_f32_32x32x16_bf16 v[48:63], v[100:103], v[116:119], v[48:63]
    v_mfma_f32_32x32x16_bf16 v[64:79], v[100:103], v[132:135], v[64:79]
    s_waitcnt lgkmcnt(0)
    s_barrier
    ds_read_b64_tr_b16 v[80:81], v4 offset:0
    ds_read_b64_tr_b16 v[82:83], v4 offset:1024
    v_mfma_f32_32x32x16_bf16 v[16:31], v[88:91], v[120:123], v[16:31]
    ds_read_b64_tr_b16 v[96:97], v5 offset:0
    ds_read_b64_tr_b16 v[98:99], v5 offset:1024
    v_mfma_f32_32x32x16_bf16 v[32:47], v[88:91], v[136:139], v[32:47]
    ds_read_b128 v[112:115], v10 offset:0
    ds_read_b128 v[128:131], v10 offset:4096
    v_mfma_f32_32x32x16_bf16 v[48:63], v[104:107], v[120:123], v[48:63]
    ds_read_b64_tr_b16 v[84:85], v4 offset:4096
    ds_read_b64_tr_b16 v[86:87], v4 offset:5120
    v_mfma_f32_32x32x16_bf16 v[64:79], v[104:107], v[136:139], v[64:79]
    ds_read_b64_tr_b16 v[100:101], v5 offset:4096
    ds_read_b64_tr_b16 v[102:103], v5 offset:5120
    v_mfma_f32_32x32x16_bf16 v[16:31], v[92:95], v[124:127], v[16:31]
    ds_read_b128 v[116:119], v11 offset:0
    ds_read_b128 v[132:135], v11 offset:4096
    v_mfma_f32_32x32x16_bf16 v[32:47], v[92:95], v[140:143], v[32:47]
    v_mfma_f32_32x32x16_bf16 v[48:63], v[108:111], v[124:127], v[48:63]
    v_mfma_f32_32x32x16_bf16 v[64:79], v[108:111], v[140:143], v[64:79]
    s_waitcnt lgkmcnt(0)
    ds_read_b64_tr_b16 v[88:89], v4 offset:8192
    ds_read_b64_tr_b16 v[90:91], v4 offset:9216
    v_mfma_f32_32x32x16_bf16 v[16:31], v[80:83], v[112:115], v[16:31]
    ds_read_b64_tr_b16 v[104:105], v5 offset:8192
    ds_read_b64_tr_b16 v[106:107], v5 offset:9216
    v_mfma_f32_32x32x16_bf16 v[32:47], v[80:83], v[128:131], v[32:47]
    ds_read_b128 v[120:123], v12 offset:0
    ds_read_b128 v[136:139], v12 offset:4096
    v_mfma_f32_32x32x16_bf16 v[48:63], v[96:99], v[112:115], v[48:63]
    ds_read_b64_tr_b16 v[92:93], v4 offset:12288
    ds_read_b64_tr_b16 v[94:95], v4 offset:13312
    v_mfma_f32_32x32x16_bf16 v[64:79], v[96:99], v[128:131], v[64:79]
    ds_read_b64_tr_b16 v[108:109], v5 offset:12288
    ds_read_b64_tr_b16 v[110:111], v5 offset:13312
    v_mfma_f32_32x32x16_bf16 v[16:31], v[84:87], v[116:119], v[16:31]
    ds_read_b128 v[124:127], v13 offset:0
    ds_read_b128 v[140:143], v13 offset:4096
    v_mfma_f32_32x32x16_bf16 v[32:47], v[84:87], v[132:135], v[32:47]
    v_mfma_f32_32x32x16_bf16 v[48:63], v[100:103], v[116:119], v[48:63]
    v_mfma_f32_32x32x16_bf16 v[64:79], v[100:103], v[132:135], v[64:79]
    s_waitcnt lgkmcnt(0)
    s_barrier
    ds_read_b64_tr_b16 v[80:81], v4 offset:32768
    ds_read_b64_tr_b16 v[82:83], v4 offset:33792
    v_mfma_f32_32x32x16_bf16 v[16:31], v[88:91], v[120:123], v[16:31]
    ds_read_b64_tr_b16 v[96:97], v5 offset:32768
    ds_read_b64_tr_b16 v[98:99], v5 offset:33792
    v_mfma_f32_32x32x16_bf16 v[32:47], v[88:91], v[136:139], v[32:47]
    ds_read_b128 v[112:115], v10 offset:32768
    ds_read_b128 v[128:131], v10 offset:36864
    v_mfma_f32_32x32x16_bf16 v[48:63], v[104:107], v[120:123], v[48:63]
    ds_read_b64_tr_b16 v[84:85], v4 offset:36864
    ds_read_b64_tr_b16 v[86:87], v4 offset:37888
    v_mfma_f32_32x32x16_bf16 v[64:79], v[104:107], v[136:139], v[64:79]
    ds_read_b64_tr_b16 v[100:101], v5 offset:36864
    ds_read_b64_tr_b16 v[102:103], v5 offset:37888
    v_mfma_f32_32x32x16_bf16 v[16:31], v[92:95], v[124:127], v[16:31]
    ds_read_b128 v[116:119], v11 offset:32768
    ds_read_b128 v[132:135], v11 offset:36864
    v_mfma_f32_32x32x16_bf16 v[32:47], v[92:95], v[140:143], v[32:47]
    v_mfma_f32_32x32x16_bf16 v[48:63], v[108:111], v[124:127], v[48:63]
    v_mfma_f32_32x32x16_bf16 v[64:79], v[108:111], v[140:143], v[64:79]
    s_waitcnt lgkmcnt(0)
    ds_read_b64_tr_b16 v[88:89], v4 offset:40960
    ds_read_b64_tr_b16 v[90:91], v4 offset:41984
    v_mfma_f32_32x32x16_bf16 v[16:31], v[80:83], v[112:115], v[16:31]
    ds_read_b64_tr_b16 v[104:105], v5 offset:40960
    ds_read_b64_tr_b16 v[106:107], v5 offset:41984
    v_mfma_f32_32x32x16_bf16 v[32:47], v[80:83], v[128:131], v[32:47]
    ds_read_b128 v[120:123], v12 offset:32768
    ds_read_b128 v[136:139], v12 offset:36864
    v_mfma_f32_32x32x16_bf16 v[48:63], v[96:99], v[112:115], v[48:63]
    ds_read_b64_tr_b16 v[92:93], v4 offset:45056
    ds_read_b64_tr_b16 v[94:95], v4 offset:46080
    v_mfma_f32_32x32x16_bf16 v[64:79], v[96:99], v[128:131], v[64:79]
    ds_read_b64_tr_b16 v[108:109], v5 offset:45056
    ds_read_b64_tr_b16 v[110:111], v5 offset:46080
    v_mfma_f32_32x32x16_bf16 v[16:31], v[84:87], v[116:119], v[16:31]
    ds_read_b128 v[124:127], v13 offset:32768
    ds_read_b128 v[140:143], v13 offset:36864
    v_mfma_f32_32x32x16_bf16 v[32:47], v[84:87], v[132:135], v[32:47]
    v_mfma_f32_32x32x16_bf16 v[48:63], v[100:103], v[116:119], v[48:63]
    v_mfma_f32_32x32x16_bf16 v[64:79], v[100:103], v[132:135], v[64:79]
    s_waitcnt lgkmcnt(0)
    s_barrier
    ds_read_b64_tr_b16 v[80:81], v2 offset:0
    ds_read_b64_tr_b16 v[82:83], v2 offset:1024
    v_mfma_f32_32x32x16_bf16 v[16:31], v[88:91], v[120:123], v[16:31]
    ds_read_b64_tr_b16 v[96:97], v3 offset:0
    ds_read_b64_tr_b16 v[98:99], v3 offset:1024
    v_mfma_f32_32x32x16_bf16 v[32:47], v[88:91], v[136:139], v[32:47]
    ds_read_b128 v[112:115], v6 offset:0
    ds_read_b128 v[128:131], v6 offset:4096
    v_mfma_f32_32x32x16_bf16 v[48:63], v[104:107], v[120:123], v[48:63]
    ds_read_b64_tr_b16 v[84:85], v2 offset:4096
    ds_read_b64_tr_b16 v[86:87], v2 offset:5120
    v_mfma_f32_32x32x16_bf16 v[64:79], v[104:107], v[136:139], v[64:79]
    ds_read_b64_tr_b16 v[100:101], v3 offset:4096
    ds_read_b64_tr_b16 v[102:103], v3 offset:5120
    v_mfma_f32_32x32x16_bf16 v[16:31], v[92:95], v[124:127], v[16:31]
    ds_read_b128 v[116:119], v7 offset:0
    ds_read_b128 v[132:135], v7 offset:4096
    v_mfma_f32_32x32x16_bf16 v[32:47], v[92:95], v[140:143], v[32:47]
    v_mfma_f32_32x32x16_bf16 v[48:63], v[108:111], v[124:127], v[48:63]
    v_mfma_f32_32x32x16_bf16 v[64:79], v[108:111], v[140:143], v[64:79]
    s_waitcnt lgkmcnt(0)
    ds_read_b64_tr_b16 v[88:89], v2 offset:8192
    ds_read_b64_tr_b16 v[90:91], v2 offset:9216
    v_mfma_f32_32x32x16_bf16 v[16:31], v[80:83], v[112:115], v[16:31]
    ds_read_b64_tr_b16 v[104:105], v3 offset:8192
    ds_read_b64_tr_b16 v[106:107], v3 offset:9216
    v_mfma_f32_32x32x16_bf16 v[32:47], v[80:83], v[128:131], v[32:47]
    ds_read_b128 v[120:123], v8 offset:0
    ds_read_b128 v[136:139], v8 offset:4096
    v_mfma_f32_32x32x16_bf16 v[48:63], v[96:99], v[112:115], v[48:63]
    ds_read_b64_tr_b16 v[92:93], v2 offset:12288
    ds_read_b64_tr_b16 v[94:95], v2 offset:13312
    v_mfma_f32_32x32x16_bf16 v[64:79], v[96:99], v[128:131], v[64:79]
    ds_read_b64_tr_b16 v[108:109], v3 offset:12288
    ds_read_b64_tr_b16 v[110:111], v3 offset:13312
    v_mfma_f32_32x32x16_bf16 v[16:31], v[84:87], v[116:119], v[16:31]
    ds_read_b128 v[124:127], v9 offset:0
    ds_read_b128 v[140:143], v9 offset:4096
    v_mfma_f32_32x32x16_bf16 v[32:47], v[84:87], v[132:135], v[32:47]
    v_mfma_f32_32x32x16_bf16 v[48:63], v[100:103], v[116:119], v[48:63]
    v_mfma_f32_32x32x16_bf16 v[64:79], v[100:103], v[132:135], v[64:79]
    s_waitcnt lgkmcnt(0)
    s_barrier
    ds_read_b64_tr_b16 v[80:81], v2 offset:32768
    ds_read_b64_tr_b16 v[82:83], v2 offset:33792
    v_mfma_f32_32x32x16_bf16 v[16:31], v[88:91], v[120:123], v[16:31]
    ds_read_b64_tr_b16 v[96:97], v3 offset:32768
    ds_read_b64_tr_b16 v[98:99], v3 offset:33792
    v_mfma_f32_32x32x16_bf16 v[32:47], v[88:91], v[136:139], v[32:47]
    ds_read_b128 v[112:115], v6 offset:32768
    ds_read_b128 v[128:131], v6 offset:36864
    v_mfma_f32_32x32x16_bf16 v[48:63], v[104:107], v[120:123], v[48:63]
    ds_read_b64_tr_b16 v[84:85], v2 offset:36864
    ds_read_b64_tr_b16 v[86:87], v2 offset:37888
    v_mfma_f32_32x32x16_bf16 v[64:79], v[104:107], v[136:139], v[64:79]
    ds_read_b64_tr_b16 v[100:101], v3 offset:36864
    ds_read_b64_tr_b16 v[102:103], v3 offset:37888
    v_mfma_f32_32x32x16_bf16 v[16:31], v[92:95], v[124:127], v[16:31]
    ds_read_b128 v[116:119], v7 offset:32768
    ds_read_b128 v[132:135], v7 offset:36864
    v_mfma_f32_32x32x16_bf16 v[32:47], v[92:95], v[140:143], v[32:47]
    v_mfma_f32_32x32x16_bf16 v[48:63], v[108:111], v[124:127], v[48:63]
    v_mfma_f32_32x32x16_bf16 v[64:79], v[108:111], v[140:143], v[64:79]
    s_waitcnt lgkmcnt(0)
    ds_read_b64_tr_b16 v[88:89], v2 offset:40960
    ds_read_b64_tr_b16 v[90:91], v2 offset:41984
    v_mfma_f32_32x32x16_bf16 v[16:31], v[80:83], v[112:115], v[16:31]
    ds_read_b64_tr_b16 v[104:105], v3 offset:40960
    ds_read_b64_tr_b16 v[106:107], v3 offset:41984
    v_mfma_f32_32x32x16_bf16 v[32:47], v[80:83], v[128:131], v[32:47]
    ds_read_b128 v[120:123], v8 offset:32768
    ds_read_b128 v[136:139], v8 offset:36864
    v_mfma_f32_32x32x16_bf16 v[48:63], v[96:99], v[112:115], v[48:63]
    ds_read_b64_tr_b16 v[92:93], v2 offset:45056
    ds_read_b64_tr_b16 v[94:95], v2 offset:46080
    v_mfma_f32_32x32x16_bf16 v[64:79], v[96:99], v[128:131], v[64:79]
    ds_read_b64_tr_b16 v[108:109], v3 offset:45056
    ds_read_b64_tr_b16 v[110:111], v3 offset:46080
    v_mfma_f32_32x32x16_bf16 v[16:31], v[84:87], v[116:119], v[16:31]
    ds_read_b128 v[124:127], v9 offset:32768
    ds_read_b128 v[140:143], v9 offset:36864
    v_mfma_f32_32x32x16_bf16 v[32:47], v[84:87], v[132:135], v[32:47]
    v_mfma_f32_32x32x16_bf16 v[48:63], v[100:103], v[116:119], v[48:63]
    v_mfma_f32_32x32x16_bf16 v[64:79], v[100:103], v[132:135], v[64:79]
    s_waitcnt lgkmcnt(0)
    s_barrier
    v_readfirstlane_b32 s48, v250
    v_readfirstlane_b32 s49, v251
    ds_read_b64 v[176:177], v181 offset:0
    ds_read_b64 v[178:179], v181 offset:256
    v_mfma_f32_32x32x16_bf16 v[16:31], v[88:91], v[120:123], v[16:31]
    ds_read_b128 v[144:147], v180 offset:0
    ds_read_b128 v[148:151], v180 offset:32
    v_mfma_f32_32x32x16_bf16 v[32:47], v[88:91], v[136:139], v[32:47]
    ds_read_b128 v[152:155], v180 offset:64
    ds_read_b128 v[156:159], v180 offset:96
    v_mfma_f32_32x32x16_bf16 v[16:31], v[92:95], v[124:127], v[16:31]
    ds_read_b128 v[160:163], v180 offset:128
    ds_read_b128 v[164:167], v180 offset:160
    v_mfma_f32_32x32x16_bf16 v[32:47], v[92:95], v[140:143], v[32:47]
    ds_read_b128 v[168:171], v180 offset:192
    ds_read_b128 v[172:175], v180 offset:224
    v_mfma_f32_32x32x16_bf16 v[48:63], v[104:107], v[120:123], v[48:63]
    v_mfma_f32_32x32x16_bf16 v[64:79], v[104:107], v[136:139], v[64:79]
    v_mfma_f32_32x32x16_bf16 v[48:63], v[108:111], v[124:127], v[48:63]
    v_mfma_f32_32x32x16_bf16 v[64:79], v[108:111], v[140:143], v[64:79]
    s_waitcnt lgkmcnt(0)
    v_mul_f32 v177, s62, v177
    v_mul_f32 v179, s62, v179
    v_pk_fma_f32 v[16:17], v[144:145], v[176:177], v[16:17] op_sel_hi:[1,0,1] neg_lo:[0,1,0] neg_hi:[0,1,0]
    v_pk_mul_f32 v[16:17], v[16:17], v[176:177] op_sel:[0,1] op_sel_hi:[1,1]
    v_pk_fma_f32 v[18:19], v[146:147], v[176:177], v[18:19] op_sel_hi:[1,0,1] neg_lo:[0,1,0] neg_hi:[0,1,0]
    v_pk_mul_f32 v[18:19], v[18:19], v[176:177] op_sel:[0,1] op_sel_hi:[1,1]
    v_cvt_pk_bf16_f32 v188, v16, v17
    v_cvt_pk_bf16_f32 v189, v18, v19
    ds_write_b64 v182, v[188:189] offset:0
    v_pk_fma_f32 v[32:33], v[144:145], v[178:179], v[32:33] op_sel_hi:[1,0,1] neg_lo:[0,1,0] neg_hi:[0,1,0]
    v_pk_mul_f32 v[32:33], v[32:33], v[178:179] op_sel:[0,1] op_sel_hi:[1,1]
    v_pk_fma_f32 v[34:35], v[146:147], v[178:179], v[34:35] op_sel_hi:[1,0,1] neg_lo:[0,1,0] neg_hi:[0,1,0]
    v_pk_mul_f32 v[34:35], v[34:35], v[178:179] op_sel:[0,1] op_sel_hi:[1,1]
    v_cvt_pk_bf16_f32 v190, v32, v33
    v_cvt_pk_bf16_f32 v191, v34, v35
    ds_write_b64 v182, v[190:191] offset:256
    ds_read_b128 v[80:83], v183 offset:0
    v_pk_fma_f32 v[20:21], v[148:149], v[176:177], v[20:21] op_sel_hi:[1,0,1] neg_lo:[0,1,0] neg_hi:[0,1,0]
    v_pk_mul_f32 v[20:21], v[20:21], v[176:177] op_sel:[0,1] op_sel_hi:[1,1]
    v_pk_fma_f32 v[22:23], v[150:151], v[176:177], v[22:23] op_sel_hi:[1,0,1] neg_lo:[0,1,0] neg_hi:[0,1,0]
    v_pk_mul_f32 v[22:23], v[22:23], v[176:177] op_sel:[0,1] op_sel_hi:[1,1]
    v_cvt_pk_bf16_f32 v192, v20, v21
    v_cvt_pk_bf16_f32 v193, v22, v23
    ds_write_b64 v182, v[192:193] offset:1024
    v_pk_fma_f32 v[36:37], v[148:149], v[178:179], v[36:37] op_sel_hi:[1,0,1] neg_lo:[0,1,0] neg_hi:[0,1,0]
    v_pk_mul_f32 v[36:37], v[36:37], v[178:179] op_sel:[0,1] op_sel_hi:[1,1]
    v_pk_fma_f32 v[38:39], v[150:151], v[178:179], v[38:39] op_sel_hi:[1,0,1] neg_lo:[0,1,0] neg_hi:[0,1,0]
    v_pk_mul_f32 v[38:39], v[38:39], v[178:179] op_sel:[0,1] op_sel_hi:[1,1]
    v_cvt_pk_bf16_f32 v194, v36, v37
    v_cvt_pk_bf16_f32 v195, v38, v39
    ds_write_b64 v182, v[194:195] offset:1280
    ds_read_b128 v[84:87], v183 offset:1024
    v_pk_fma_f32 v[24:25], v[152:153], v[176:177], v[24:25] op_sel_hi:[1,0,1] neg_lo:[0,1,0] neg_hi:[0,1,0]
    v_pk_mul_f32 v[24:25], v[24:25], v[176:177] op_sel:[0,1] op_sel_hi:[1,1]
    v_pk_fma_f32 v[26:27], v[154:155], v[176:177], v[26:27] op_sel_hi:[1,0,1] neg_lo:[0,1,0] neg_hi:[0,1,0]
    v_pk_mul_f32 v[26:27], v[26:27], v[176:177] op_sel:[0,1] op_sel_hi:[1,1]
    v_cvt_pk_bf16_f32 v196, v24, v25
    v_cvt_pk_bf16_f32 v197, v26, v27
    ds_write_b64 v182, v[196:197] offset:2048
    v_pk_fma_f32 v[40:41], v[152:153], v[178:179], v[40:41] op_sel_hi:[1,0,1] neg_lo:[0,1,0] neg_hi:[0,1,0]
    v_pk_mul_f32 v[40:41], v[40:41], v[178:179] op_sel:[0,1] op_sel_hi:[1,1]
    v_pk_fma_f32 v[42:43], v[154:155], v[178:179], v[42:43] op_sel_hi:[1,0,1] neg_lo:[0,1,0] neg_hi:[0,1,0]
    v_pk_mul_f32 v[42:43], v[42:43], v[178:179] op_sel:[0,1] op_sel_hi:[1,1]
    v_cvt_pk_bf16_f32 v198, v40, v41
    v_cvt_pk_bf16_f32 v199, v42, v43
    ds_write_b64 v182, v[198:199] offset:2304
    ds_read_b128 v[88:91], v183 offset:2048
    s_waitcnt lgkmcnt(6)
    buffer_store_dwordx4 v[80:83], v184, s[24:27], s61 offen sc1
    s_add_u32 s61, s61, 33280
    v_pk_fma_f32 v[28:29], v[156:157], v[176:177], v[28:29] op_sel_hi:[1,0,1] neg_lo:[0,1,0] neg_hi:[0,1,0]
    v_pk_mul_f32 v[28:29], v[28:29], v[176:177] op_sel:[0,1] op_sel_hi:[1,1]
    v_pk_fma_f32 v[30:31], v[158:159], v[176:177], v[30:31] op_sel_hi:[1,0,1] neg_lo:[0,1,0] neg_hi:[0,1,0]
    v_pk_mul_f32 v[30:31], v[30:31], v[176:177] op_sel:[0,1] op_sel_hi:[1,1]
    v_cvt_pk_bf16_f32 v200, v28, v29
    v_cvt_pk_bf16_f32 v201, v30, v31
    ds_write_b64 v182, v[200:201] offset:3072
    v_pk_fma_f32 v[44:45], v[156:157], v[178:179], v[44:45] op_sel_hi:[1,0,1] neg_lo:[0,1,0] neg_hi:[0,1,0]
    v_pk_mul_f32 v[44:45], v[44:45], v[178:179] op_sel:[0,1] op_sel_hi:[1,1]
    v_pk_fma_f32 v[46:47], v[158:159], v[178:179], v[46:47] op_sel_hi:[1,0,1] neg_lo:[0,1,0] neg_hi:[0,1,0]
    v_pk_mul_f32 v[46:47], v[46:47], v[178:179] op_sel:[0,1] op_sel_hi:[1,1]
    v_cvt_pk_bf16_f32 v202, v44, v45
    v_cvt_pk_bf16_f32 v203, v46, v47
    ds_write_b64 v182, v[202:203] offset:3328
    ds_read_b128 v[92:95], v183 offset:3072
    s_waitcnt lgkmcnt(6)
    buffer_store_dwordx4 v[84:87], v184, s[24:27], s61 offen sc1
    s_add_u32 s61, s61, 33280
    v_pk_fma_f32 v[48:49], v[160:161], v[176:177], v[48:49] op_sel_hi:[1,0,1] neg_lo:[0,1,0] neg_hi:[0,1,0]
    v_pk_mul_f32 v[48:49], v[48:49], v[176:177] op_sel:[0,1] op_sel_hi:[1,1]
    v_pk_fma_f32 v[50:51], v[162:163], v[176:177], v[50:51] op_sel_hi:[1,0,1] neg_lo:[0,1,0] neg_hi:[0,1,0]
    v_pk_mul_f32 v[50:51], v[50:51], v[176:177] op_sel:[0,1] op_sel_hi:[1,1]
    v_cvt_pk_bf16_f32 v204, v48, v49
    v_cvt_pk_bf16_f32 v205, v50, v51
    ds_write_b64 v182, v[204:205] offset:4096
    v_pk_fma_f32 v[64:65], v[160:161], v[178:179], v[64:65] op_sel_hi:[1,0,1] neg_lo:[0,1,0] neg_hi:[0,1,0]
    v_pk_mul_f32 v[64:65], v[64:65], v[178:179] op_sel:[0,1] op_sel_hi:[1,1]
    v_pk_fma_f32 v[66:67], v[162:163], v[178:179], v[66:67] op_sel_hi:[1,0,1] neg_lo:[0,1,0] neg_hi:[0,1,0]
    v_pk_mul_f32 v[66:67], v[66:67], v[178:179] op_sel:[0,1] op_sel_hi:[1,1]
    v_cvt_pk_bf16_f32 v206, v64, v65
    v_cvt_pk_bf16_f32 v207, v66, v67
    ds_write_b64 v182, v[206:207] offset:4352
    ds_read_b128 v[96:99], v183 offset:4096
    s_waitcnt lgkmcnt(6)
    buffer_store_dwordx4 v[88:91], v184, s[24:27], s61 offen sc1
    s_add_u32 s61, s61, 33280
    v_pk_fma_f32 v[52:53], v[164:165], v[176:177], v[52:53] op_sel_hi:[1,0,1] neg_lo:[0,1,0] neg_hi:[0,1,0]
    v_pk_mul_f32 v[52:53], v[52:53], v[176:177] op_sel:[0,1] op_sel_hi:[1,1]
    v_pk_fma_f32 v[54:55], v[166:167], v[176:177], v[54:55] op_sel_hi:[1,0,1] neg_lo:[0,1,0] neg_hi:[0,1,0]
    v_pk_mul_f32 v[54:55], v[54:55], v[176:177] op_sel:[0,1] op_sel_hi:[1,1]
    v_cvt_pk_bf16_f32 v208, v52, v53
    v_cvt_pk_bf16_f32 v209, v54, v55
    ds_write_b64 v182, v[208:209] offset:5120
    v_pk_fma_f32 v[68:69], v[164:165], v[178:179], v[68:69] op_sel_hi:[1,0,1] neg_lo:[0,1,0] neg_hi:[0,1,0]
    v_pk_mul_f32 v[68:69], v[68:69], v[178:179] op_sel:[0,1] op_sel_hi:[1,1]
    v_pk_fma_f32 v[70:71], v[166:167], v[178:179], v[70:71] op_sel_hi:[1,0,1] neg_lo:[0,1,0] neg_hi:[0,1,0]
    v_pk_mul_f32 v[70:71], v[70:71], v[178:179] op_sel:[0,1] op_sel_hi:[1,1]
    v_cvt_pk_bf16_f32 v210, v68, v69
    v_cvt_pk_bf16_f32 v211, v70, v71
    ds_write_b64 v182, v[210:211] offset:5376
    ds_read_b128 v[100:103], v183 offset:5120
    s_waitcnt lgkmcnt(6)
    buffer_store_dwordx4 v[92:95], v184, s[24:27], s61 offen sc1
    s_add_u32 s61, s61, 33280
    v_pk_fma_f32 v[56:57], v[168:169], v[176:177], v[56:57] op_sel_hi:[1,0,1] neg_lo:[0,1,0] neg_hi:[0,1,0]
    v_pk_mul_f32 v[56:57], v[56:57], v[176:177] op_sel:[0,1] op_sel_hi:[1,1]
    v_pk_fma_f32 v[58:59], v[170:171], v[176:177], v[58:59] op_sel_hi:[1,0,1] neg_lo:[0,1,0] neg_hi:[0,1,0]
    v_pk_mul_f32 v[58:59], v[58:59], v[176:177] op_sel:[0,1] op_sel_hi:[1,1]
    v_cvt_pk_bf16_f32 v212, v56, v57
    v_cvt_pk_bf16_f32 v213, v58, v59
    ds_write_b64 v182, v[212:213] offset:6144
    v_pk_fma_f32 v[72:73], v[168:169], v[178:179], v[72:73] op_sel_hi:[1,0,1] neg_lo:[0,1,0] neg_hi:[0,1,0]
    v_pk_mul_f32 v[72:73], v[72:73], v[178:179] op_sel:[0,1] op_sel_hi:[1,1]
    v_pk_fma_f32 v[74:75], v[170:171], v[178:179], v[74:75] op_sel_hi:[1,0,1] neg_lo:[0,1,0] neg_hi:[0,1,0]
    v_pk_mul_f32 v[74:75], v[74:75], v[178:179] op_sel:[0,1] op_sel_hi:[1,1]
    v_cvt_pk_bf16_f32 v214, v72, v73
    v_cvt_pk_bf16_f32 v215, v74, v75
    ds_write_b64 v182, v[214:215] offset:6400
    ds_read_b128 v[104:107], v183 offset:6144
    s_waitcnt lgkmcnt(6)
    buffer_store_dwordx4 v[96:99], v184, s[24:27], s61 offen sc1
    s_add_u32 s61, s61, 33280
    v_pk_fma_f32 v[60:61], v[172:173], v[176:177], v[60:61] op_sel_hi:[1,0,1] neg_lo:[0,1,0] neg_hi:[0,1,0]
    v_pk_mul_f32 v[60:61], v[60:61], v[176:177] op_sel:[0,1] op_sel_hi:[1,1]
    v_pk_fma_f32 v[62:63], v[174:175], v[176:177], v[62:63] op_sel_hi:[1,0,1] neg_lo:[0,1,0] neg_hi:[0,1,0]
    v_pk_mul_f32 v[62:63], v[62:63], v[176:177] op_sel:[0,1] op_sel_hi:[1,1]
    v_cvt_pk_bf16_f32 v216, v60, v61
    v_cvt_pk_bf16_f32 v217, v62, v63
    ds_write_b64 v182, v[216:217] offset:7168
    v_pk_fma_f32 v[76:77], v[172:173], v[178:179], v[76:77] op_sel_hi:[1,0,1] neg_lo:[0,1,0] neg_hi:[0,1,0]
    v_pk_mul_f32 v[76:77], v[76:77], v[178:179] op_sel:[0,1] op_sel_hi:[1,1]
    v_pk_fma_f32 v[78:79], v[174:175], v[178:179], v[78:79] op_sel_hi:[1,0,1] neg_lo:[0,1,0] neg_hi:[0,1,0]
    v_pk_mul_f32 v[78:79], v[78:79], v[178:179] op_sel:[0,1] op_sel_hi:[1,1]
    v_cvt_pk_bf16_f32 v218, v76, v77
    v_cvt_pk_bf16_f32 v219, v78, v79
    ds_write_b64 v182, v[218:219] offset:7424
    ds_read_b128 v[108:111], v183 offset:7168
    s_waitcnt lgkmcnt(6)
    buffer_store_dwordx4 v[100:103], v184, s[24:27], s61 offen sc1
    s_add_u32 s61, s61, 33280
    s_waitcnt lgkmcnt(3)
    buffer_store_dwordx4 v[104:107], v184, s[24:27], s61 offen sc1
    s_add_u32 s61, s61, 33280
    s_waitcnt lgkmcnt(0)
    buffer_store_dwordx4 v[108:111], v184, s[24:27], s61 offen sc1
    s_add_u32 s61, s61, 33280
    s_lshl_b32 s59, s57, 10
    s_lshl_b32 s60, s56, 6
    s_add_u32 s59, s59, s60
    s_add_u32 s59, s59, 21168128
    s_cmp_eq_u32 s46, 0
    s_cselect_b32 s47, s59, 0
L_A_done:
    v_lshlrev_b32 v2, 4, v1
    s_mul_i32 s62, s92, 5
    s_lshr_b32 s52, s62, 5
    s_add_u32 s53, s62, 4
    s_lshr_b32 s53, s53, 5
    s_sub_u32 s53, s53, s52
    s_lshl_b32 s53, s53, 7
    s_lshl_b32 s66, s52, 10
    s_add_u32 s66, s66, 21168128
    v_bfe_u32 v120, v1, 4, 1
    v_mul_lo_u32 v120, v120, s53
    v_lshrrev_b32 v121, 5, v1
    v_mul_u32_u24 v121, 640, v121
    v_and_b32 v122, 15, v1
    v_lshl_add_u32 v121, v122, 3, v121
    v_add3_u32 v248, v121, v120, 64
    v_add_u32 v248, 576, v248
    v_bfe_u32 v120, v1, 1, 1
    v_mul_lo_u32 v120, v120, s53
    v_lshrrev_b32 v121, 2, v1
    v_min_u32 v121, 0, v121
    v_mul_u32_u24 v121, 640, v121
    v_and_b32 v122, 1, v1
    v_lshl_add_u32 v121, v122, 3, v121
    s_lshl_b32 s54, s93, 4
    v_add3_u32 v124, v121, v120, s54
    s_add_u32 s52, s46, 0
    s_lshr_b32 s53, s52, 1
    s_and_b32 s52, s52, 1
    s_lshl_b32 s52, s52, 10
    s_cmp_ge_u32 s53, 5
    s_cselect_b32 s54, 155, 0
    s_add_u32 s55, s53, s54
    s_add_u32 s55, s55, s62
    s_add_u32 s55, s55, 160
    s_mul_i32 s55, s55, 16640
    s_add_u32 s55, s55, s52
    s_lshl_b32 s58, s53, 11
    s_add_u32 s58, s58, s52
    s_max_u32 s53, s53, 5
    s_sub_u32 s53, s53, 5
    s_lshl_b32 s53, s53, 5
    s_add_u32 s58, s58, s53
    s_add_u32 s52, s46, 8
    s_lshr_b32 s53, s52, 1
    s_and_b32 s52, s52, 1
    s_lshl_b32 s52, s52, 10
    s_cmp_ge_u32 s53, 5
    s_cselect_b32 s54, 155, 0
    s_add_u32 s56, s53, s54
    s_add_u32 s56, s56, s62
    s_add_u32 s56, s56, 160
    s_mul_i32 s56, s56, 16640
    s_add_u32 s56, s56, s52
    s_lshl_b32 s59, s53, 11
    s_add_u32 s59, s59, s52
    s_max_u32 s53, s53, 5
    s_sub_u32 s53, s53, 5
    s_lshl_b32 s53, s53, 5
    s_add_u32 s59, s59, s53
    s_add_u32 s52, s46, 16
    s_lshr_b32 s53, s52, 1
    s_and_b32 s52, s52, 1
    s_lshl_b32 s52, s52, 10
    s_cmp_ge_u32 s53, 5
    s_cselect_b32 s54, 155, 0
    s_add_u32 s57, s53, s54
    s_add_u32 s57, s57, s62
    s_add_u32 s57, s57, 160
    s_mul_i32 s57, s57, 16640
    s_add_u32 s57, s57, s52
    s_lshl_b32 s60, s53, 11
    s_add_u32 s60, s60, s52
    s_max_u32 s53, s53, 5
    s_sub_u32 s53, s53, 5
    s_lshl_b32 s53, s53, 5
    s_add_u32 s60, s60, s53
    s_and_b32 s61, s93, 1
    s_add_u32 s61, s61, s92
    s_and_b32 s61, s61, 7
    v_mov_b32 v4, s48
    v_mov_b32 v5, s49
    v_lshlrev_b32 v6, 3, v1
    s_cmp_eq_u32 s47, 0
    s_waitcnt vmcnt(0)
    s_barrier
    s_cbranch_scc1 Lff_9
    s_mov_b64 exec, 0xff
    buffer_store_dwordx2 v[4:5], v6, s[24:27], s47 offen sc1
    s_mov_b64 exec, -1
Lff_9:
    s_cmp_lg_u32 s46, 5
    s_cbranch_scc1 Lc3_10
    s_mov_b32 s52, s45
L_pc_c:
    s_getpc_b64 s[82:83]
    s_mul_i32 s52, s52, 896
    v_lshlrev_b32 v252, 7, v1
    v_add_u32 v252, s52, v252
    v_min_u32 v252, 0x6830, v252
    v_mov_b32 v253, s83
    v_add_co_u32 v252, vcc, s82, v252
    s_nop 1
    v_addc_co_u32 v253, vcc, 0, v253, vcc
    s_mov_b32 exec_lo, 0x7f
    s_mov_b32 exec_hi, 0
    global_load_dword v254, v[252:253], off
    s_mov_b64 exec, -1
Lc3_10:
    s_lshl_b32 s96, s44, 2
    s_add_u32 s96, s96, s50
    s_lshl_b32 s95, s96, 2
    s_mul_i32 s97, s51, 160
    s_lshr_b32 s63, s46, 2
    v_lshlrev_b32 v80, 2, v0
    v_add_u32 v80, 161696, v80
    v_and_b32 v81, 1, v1
    v_cmp_eq_u32 vcc, 0, v81
    v_mov_b32 v81, 0x3f80
    s_nop 0
    v_cndmask_b32 v81, 0, v81, vcc
    ds_write_b32 v80, v81
    s_lshl_b32 s52, s63, 10
    s_add_u32 s52, s52, 140800
    v_and_b32 v80, 31, v1
    v_lshrrev_b32 v81, 5, v1
    v_lshlrev_b32 v82, 12, v81
    v_lshl_add_u32 v3, v80, 3, v82
    v_add_u32 v3, s52, v3
    v_add_u32 v4, 256, v3
    v_lshlrev_b32 v5, 3, v1
    s_add_u32 s53, s52, 8192
    v_add_u32 v5, s53, v5
    v_bfe_u32 v82, v1, 2, 2
    v_lshl_add_u32 v82, v81, 3, v82
    v_lshlrev_b32 v82, 3, v82
    v_and_b32 v83, 3, v1
    v_bfe_u32 v7, v1, 4, 1
    v_lshl_add_u32 v83, v7, 2, v83
    v_mul_u32_u24 v6, 2080, v83
    s_add_u32 s53, s52, 10240
    v_add_u32 v6, s53, v6
    v_cmp_lt_u32 vcc, 4, v83
    v_mov_b32 v83, 161696
    s_nop 0
    v_cndmask_b32 v6, v6, v83, vcc
    v_add_u32 v6, v6, v82
    v_cndmask_b32 v7, -1, 0, vcc
    v_mov_b32 v8, 0xdddddddd
    s_and_b32 s52, s46, 3
    s_lshl_b32 s52, s52, 1
    s_lshl_b32 s53, s93, 3
    s_add_u32 s52, s52, s53
    s_add_u32 s67, s52, s63
    v_mov_b32 v48, 0
    v_mov_b32 v49, 0
    v_mov_b32 v50, 0
    v_mov_b32 v51, 0
    v_mov_b32 v52, 0
    v_mov_b32 v53, 0
    v_mov_b32 v54, 0
    v_mov_b32 v55, 0
    v_mov_b32 v56, 0
    v_mov_b32 v57, 0
    v_mov_b32 v58, 0
    v_mov_b32 v59, 0
    v_mov_b32 v60, 0
    v_mov_b32 v61, 0
    v_mov_b32 v62, 0
    v_mov_b32 v63, 0
    v_mov_b32 v64, 0
    v_mov_b32 v65, 0
    v_mov_b32 v66, 0
    v_mov_b32 v67, 0
    v_mov_b32 v68, 0
    v_mov_b32 v69, 0
    v_mov_b32 v70, 0
    v_mov_b32 v71, 0
    v_mov_b32 v72, 0
    v_mov_b32 v73, 0
    v_mov_b32 v74, 0
    v_mov_b32 v75, 0
    v_mov_b32 v76, 0
    v_mov_b32 v77, 0
    v_mov_b32 v78, 0
    v_mov_b32 v79, 0
    s_xor_b32 s52, s67, 1
    s_and_b32 s52, s52, 7
    s_lshl_b32 s52, s52, 8
    s_add_u32 s52, s52, 65536
    v_and_b32 v80, 31, v1
    v_lshlrev_b32 v80, 3, v80
    v_add_u32 v86, s52, v80
    v_lshl_add_u32 v84, v81, 12, v86
    s_xor_b32 s52, s67, 0
    s_and_b32 s52, s52, 7
    s_lshl_b32 s52, s52, 8
    s_add_u32 s52, s52, 65536
    v_and_b32 v80, 31, v1
    v_lshlrev_b32 v80, 3, v80
    v_add_u32 v87, s52, v80
    v_lshl_add_u32 v85, v81, 12, v87
    s_mul_i32 s69, s51, 593920
    s_add_u32 s69, s69, 21233664
    s_lshl_b32 s74, s46, 8
    s_add_u32 s74, s74, s2
    s_cmp_lt_u32 s74, 864
    s_cselect_b32 s68, 1, 0
    s_mov_b32 s84, s20
    s_mov_b32 s85, s21
    s_mov_b32 s86, s22
    s_mov_b32 s87, 0x00020000
    v_mov_b32 v176, 0
    v_mov_b32 v177, 0
    v_mov_b32 v178, 0
    v_mov_b32 v179, 0
    v_mov_b32 v180, 0
    v_mov_b32 v181, 0
    v_mov_b32 v9, 0
    s_cbranch_scc0 Lpsk_11
    s_and_b32 s77, s74, 7
    s_lshr_b32 s75, s74, 3
    s_lshl_b32 s72, s77, 10
    s_lshl_b32 s52, s75, 3
    s_add_u32 s72, s72, s52
    s_add_u32 s72, s72, 20987904
    s_mul_i32 s71, s77, 593920
    s_add_u32 s71, s71, 21233664
    s_cmp_ge_u32 s75, 68
    s_cbranch_scc1 Lpw1_13
    s_mul_i32 s52, s75, 5120
    s_add_u32 s71, s71, s52
    s_mov_b32 s73, 0
    s_mov_b32 s79, 1280
    s_mul_i32 s70, s77, 160
    s_cmp_ge_u32 s75, 48
    s_cbranch_scc1 Lpwo_12
    s_mov_b32 s84, s20
    s_mov_b32 s85, s21
    s_mov_b32 s86, s22
    s_mov_b32 s78, 16
    s_mov_b32 s88, 4
    s_mov_b32 s89, 8
    s_lshl_b32 s53, s75, 5
    s_branch Lpd_14
Lpwo_12:
    s_mov_b32 s84, s12
    s_mov_b32 s85, s13
    s_mov_b32 s86, s14
    s_sub_u32 s75, s75, 48
    s_cmp_ge_u32 s75, 10
    s_cselect_b32 s54, 1, 0
    s_mul_i32 s52, s54, 10
    s_sub_u32 s75, s75, s52
    s_mul_i32 s53, s75, 40
    s_mul_i32 s52, s75, 160
    s_sub_u32 s52, s52, 1264
    s_cmp_ge_u32 s75, 8
    s_cselect_b32 s53, s52, s53
    s_cselect_b32 s78, 80, 20
    s_cselect_b32 s88, 20, 8
    s_cselect_b32 s89, 40, 4
    s_mul_i32 s52, s54, 320
    s_add_u32 s53, s53, s52
    s_branch Lpd_14
Lpw1_13:
    s_mov_b32 s84, s16
    s_mov_b32 s85, s17
    s_mov_b32 s86, s18
    s_sub_u32 s75, s75, 68
    s_mul_i32 s52, s75, 6144
    s_add_u32 s71, s71, s52
    s_add_u32 s71, s71, 348160
    s_mov_b32 s73, 1
    s_mov_b32 s79, 3072
    s_mul_i32 s70, s77, 384
    s_cmp_ge_u32 s75, 20
    s_cselect_b32 s52, 192, 0
    s_cselect_b32 s53, 20, 0
    s_add_u32 s70, s70, s52
    s_sub_u32 s75, s75, s53
    s_cmp_ge_u32 s75, 10
    s_cselect_b32 s54, 1, 0
    s_mul_i32 s52, s54, 10
    s_sub_u32 s75, s75, s52
    s_lshr_b32 s53, s75, 1
    s_mul_i32 s53, s53, 80
    s_and_b32 s52, s75, 1
    s_lshl_b32 s52, s52, 5
    s_add_u32 s53, s53, s52
    s_mul_i32 s52, s75, 160
    s_sub_u32 s52, s52, 1216
    s_cmp_ge_u32 s75, 8
    s_cselect_b32 s53, s52, s53
    s_cselect_b32 s88, 80, 16
    s_mov_b32 s78, 8
    s_mov_b32 s89, 4
    s_mul_i32 s52, s54, 320
    s_add_u32 s53, s53, s52
Lpd_14:
    s_mul_i32 s53, s53, s79
    s_add_u32 s70, s70, s53
    v_add_u32 v92, 0, v1
    v_mul_u32_u24 v93, 171, v92
    v_lshrrev_b32 v93, 11, v93
    v_mul_u32_u24 v94, 12, v93
    v_sub_u32 v94, v92, v94
    v_and_b32 v92, 3, v93
    v_lshrrev_b32 v95, 4, v93
    v_mad_u32_u24 v92, v95, s78, v92
    v_bfe_u32 v95, v93, 3, 1
    v_mad_u32_u24 v92, v95, s88, v92
    v_bfe_u32 v95, v93, 2, 1
    v_mad_u32_u24 v92, v95, s89, v92
    v_mul_u32_u24 v92, s79, v92
    v_lshl_add_u32 v176, v94, 4, v92
    v_add_u32 v92, 64, v1
    v_mul_u32_u24 v93, 171, v92
    v_lshrrev_b32 v93, 11, v93
    v_mul_u32_u24 v94, 12, v93
    v_sub_u32 v94, v92, v94
    v_and_b32 v92, 3, v93
    v_lshrrev_b32 v95, 4, v93
    v_mad_u32_u24 v92, v95, s78, v92
    v_bfe_u32 v95, v93, 3, 1
    v_mad_u32_u24 v92, v95, s88, v92
    v_bfe_u32 v95, v93, 2, 1
    v_mad_u32_u24 v92, v95, s89, v92
    v_mul_u32_u24 v92, s79, v92
    v_lshl_add_u32 v177, v94, 4, v92
    v_add_u32 v92, 128, v1
    v_mul_u32_u24 v93, 171, v92
    v_lshrrev_b32 v93, 11, v93
    v_mul_u32_u24 v94, 12, v93
    v_sub_u32 v94, v92, v94
    v_and_b32 v92, 3, v93
    v_lshrrev_b32 v95, 4, v93
    v_mad_u32_u24 v92, v95, s78, v92
    v_bfe_u32 v95, v93, 3, 1
    v_mad_u32_u24 v92, v95, s88, v92
    v_bfe_u32 v95, v93, 2, 1
    v_mad_u32_u24 v92, v95, s89, v92
    v_mul_u32_u24 v92, s79, v92
    v_lshl_add_u32 v178, v94, 4, v92
    v_add_u32 v92, 192, v1
    v_mul_u32_u24 v93, 171, v92
    v_lshrrev_b32 v93, 11, v93
    v_mul_u32_u24 v94, 12, v93
    v_sub_u32 v94, v92, v94
    v_and_b32 v92, 3, v93
    v_lshrrev_b32 v95, 4, v93
    v_mad_u32_u24 v92, v95, s78, v92
    v_bfe_u32 v95, v93, 3, 1
    v_mad_u32_u24 v92, v95, s88, v92
    v_bfe_u32 v95, v93, 2, 1
    v_mad_u32_u24 v92, v95, s89, v92
    v_mul_u32_u24 v92, s79, v92
    v_lshl_add_u32 v179, v94, 4, v92
    v_add_u32 v92, 256, v1
    v_mul_u32_u24 v93, 171, v92
    v_lshrrev_b32 v93, 11, v93
    v_mul_u32_u24 v94, 12, v93
    v_sub_u32 v94, v92, v94
    v_and_b32 v92, 3, v93
    v_lshrrev_b32 v95, 4, v93
    v_mad_u32_u24 v92, v95, s78, v92
    v_bfe_u32 v95, v93, 3, 1
    v_mad_u32_u24 v92, v95, s88, v92
    v_bfe_u32 v95, v93, 2, 1
    v_mad_u32_u24 v92, v95, s89, v92
    v_mul_u32_u24 v92, s79, v92
    v_lshl_add_u32 v180, v94, 4, v92
    v_add_u32 v92, 320, v1
    v_mul_u32_u24 v93, 171, v92
    v_lshrrev_b32 v93, 11, v93
    v_mul_u32_u24 v94, 12, v93
    v_sub_u32 v94, v92, v94
    v_and_b32 v92, 3, v93
    v_lshrrev_b32 v95, 4, v93
    v_mad_u32_u24 v92, v95, s78, v92
    v_bfe_u32 v95, v93, 3, 1
    v_mad_u32_u24 v92, v95, s88, v92
    v_bfe_u32 v95, v93, 2, 1
    v_mad_u32_u24 v92, v95, s89, v92
    v_mul_u32_u24 v92, s79, v92
    v_lshl_add_u32 v181, v94, 4, v92
    v_lshrrev_b32 v92, 5, v1
    v_lshlrev_b32 v92, 4, v92
    v_bfe_u32 v93, v1, 2, 3
    v_add_u32 v92, v92, v93
    v_mul_u32_u24 v92, 192, v92
    v_and_b32 v93, 3, v1
    v_lshl_add_u32 v9, v93, 3, v92
    s_mul_i32 s52, s46, 6144
    v_add_u32 v9, s52, v9
Lpsk_11:
    s_cmp_eq_u32 s46, 2
    s_cselect_b64 vcc, -1, 0
    v_cndmask_b32 v124, v124, v248, vcc
    s_lshr_b32 s52, s46, 1
    v_lshlrev_b32 v124, 3, v124
    s_cmp_lg_u32 s52, 1
    s_cbranch_scc1 Lnp_15
    s_mov_b32 s94, 0
Lpoll_16:
    buffer_load_dwordx2 v[126:127], v124, s[24:27], s66 offen sc1
    s_add_u32 s94, s94, 1
    s_waitcnt vmcnt(0)
    v_cmp_ne_u64 vcc, s[48:49], v[126:127]
    s_cbranch_vccz Lpolle_17
    s_cmp_le_u32 s94, 0x40000
    s_cbranch_scc1 Lpoll_16
Lpolle_17:
    s_cmp_lg_u32 s46, 3
    s_cbranch_scc1 Lnp_15
    s_lshl_b32 s54, s93, 11
    s_mul_i32 s52, s62, 16640
    s_add_u32 s54, s54, s52
    s_mov_b32 m0, 65536
    s_nop 0
    buffer_load_dwordx4 v2, s[24:27], s54 offen offset:0 sc1 lds
    buffer_load_dwordx4 v2, s[24:27], s54 offen offset:1024 sc1 lds
    s_add_u32 s54, s54, 16640
    s_mov_b32 m0, 67584
    s_nop 0
    buffer_load_dwordx4 v2, s[24:27], s54 offen offset:0 sc1 lds
    buffer_load_dwordx4 v2, s[24:27], s54 offen offset:1024 sc1 lds
    s_add_u32 s54, s54, 16640
    s_mov_b32 m0, 69632
    s_nop 0
    buffer_load_dwordx4 v2, s[24:27], s54 offen offset:0 sc1 lds
    buffer_load_dwordx4 v2, s[24:27], s54 offen offset:1024 sc1 lds
    s_add_u32 s54, s54, 16640
    s_mov_b32 m0, 71680
    s_nop 0
    buffer_load_dwordx4 v2, s[24:27], s54 offen offset:0 sc1 lds
    buffer_load_dwordx4 v2, s[24:27], s54 offen offset:1024 sc1 lds
    s_add_u32 s54, s54, 16640
    s_mov_b32 m0, 73728
    s_nop 0
    buffer_load_dwordx4 v2, s[24:27], s54 offen offset:0 sc1 lds
    buffer_load_dwordx4 v2, s[24:27], s54 offen offset:1024 sc1 lds
    s_add_u32 s54, s54, 16640
Lnp_15:
    s_barrier
    s_lshl_b32 s52, s61, 11
    s_add_u32 s61, s61, 1
    s_and_b32 s61, s61, 7
    s_add_u32 m0, s58, 140800
    s_add_u32 s53, s55, s52
    buffer_load_dwordx4 v2, s[24:27], s53 offen sc1 lds
    s_add_u32 m0, s59, 140800
    s_add_u32 s53, s56, s52
    buffer_load_dwordx4 v2, s[24:27], s53 offen sc1 lds
    s_cmp_ge_u32 s46, 4
    s_cbranch_scc1 Ld_18
    s_add_u32 m0, s60, 140800
    s_add_u32 s53, s57, s52
    buffer_load_dwordx4 v2, s[24:27], s53 offen sc1 lds
Ld_18:
    s_waitcnt vmcnt(0) lgkmcnt(0)
    s_barrier
    ds_read2st64_b64 v[16:19], v84 offset0:0 offset1:4
    ds_read_b64 v[24:25], v86 offset:8192
    ds_read2st64_b64 v[20:23], v85 offset0:0 offset1:4
    ds_read_b64 v[28:29], v87 offset:8192
    ds_read2st64_b64 v[112:115], v3 offset0:0 offset1:4
    ds_read_b64 v[10:11], v5 offset:0
    ds_read_b64_tr_b16 v[120:121], v6 offset:0
    ds_read_b64_tr_b16 v[122:123], v6 offset:32
    ds_read_b64_tr_b16 v[124:125], v6 offset:128
    ds_read_b64_tr_b16 v[126:127], v6 offset:160
    v_cmp_gt_u32 vcc, 32, v1
    s_waitcnt lgkmcnt(6)
    s_nop 0
    v_cndmask_b32 v26, v24, 0, vcc
    v_cndmask_b32 v24, 0, v24, vcc
    v_cndmask_b32 v27, v25, 0, vcc
    v_cndmask_b32 v25, 0, v25, vcc
    v_cndmask_b32 v30, v28, 0, vcc
    v_cndmask_b32 v28, 0, v28, vcc
    v_cndmask_b32 v31, v29, 0, vcc
    v_cndmask_b32 v29, 0, v29, vcc
    s_waitcnt lgkmcnt(4)
    v_mfma_f32_32x32x8_bf16 v[80:95], v[10:11], v[24:25], 0
    v_mfma_f32_32x32x8_bf16 v[96:111], v[10:11], v[28:29], 0
    v_mfma_f32_32x32x16_bf16 v[80:95], v[112:115], v[16:19], v[80:95]
    v_mfma_f32_32x32x16_bf16 v[96:111], v[112:115], v[20:23], v[96:111]
    s_lshl_b32 s52, s61, 11
    s_add_u32 s61, s61, 1
    s_and_b32 s61, s61, 7
    s_add_u32 m0, s58, 99328
    s_add_u32 s53, s55, s52
    buffer_load_dwordx4 v2, s[24:27], s53 offen sc1 lds
    s_add_u32 m0, s59, 99328
    s_add_u32 s53, s56, s52
    buffer_load_dwordx4 v2, s[24:27], s53 offen sc1 lds
    s_cmp_ge_u32 s46, 4
    s_cbranch_scc1 Ld_19
    s_add_u32 m0, s60, 99328
    s_add_u32 s53, s57, s52
    buffer_load_dwordx4 v2, s[24:27], s53 offen sc1 lds
Ld_19:
    v_max3_f32 v32, v80, v81, v82
    v_max3_f32 v32, v32, v83, v84
    v_max3_f32 v32, v32, v85, v86
    v_max3_f32 v32, v32, v87, v88
    v_max3_f32 v32, v32, v89, v90
    v_max3_f32 v32, v32, v91, v92
    v_max3_f32 v32, v32, v93, v94
    v_max3_f32 v33, v96, v97, v98
    v_max3_f32 v33, v33, v99, v100
    v_max3_f32 v33, v33, v101, v102
    v_max3_f32 v33, v33, v103, v104
    v_max3_f32 v33, v33, v105, v106
    v_max3_f32 v33, v33, v107, v108
    v_max3_f32 v33, v33, v109, v110
    v_max3_f32 v32, v32, v95, v111
    v_max_f32 v32, v32, v33
    v_mov_b32 v33, v32
    s_nop 1
    v_permlane32_swap_b32 v32, v33
    v_max_f32 v0, v32, v33
    v_sub_f32 v80, v80, v0
    v_sub_f32 v81, v81, v0
    v_sub_f32 v82, v82, v0
    v_sub_f32 v83, v83, v0
    v_sub_f32 v84, v84, v0
    v_sub_f32 v85, v85, v0
    v_sub_f32 v86, v86, v0
    v_sub_f32 v87, v87, v0
    v_sub_f32 v88, v88, v0
    v_sub_f32 v89, v89, v0
    v_sub_f32 v90, v90, v0
    v_sub_f32 v91, v91, v0
    v_sub_f32 v92, v92, v0
    v_sub_f32 v93, v93, v0
    v_sub_f32 v94, v94, v0
    v_sub_f32 v95, v95, v0
    v_sub_f32 v32, 0, v0
    v_sub_f32 v33, 0, v0
    v_sub_f32 v34, 0, v0
    v_sub_f32 v35, 0, v0
    v_sub_f32 v36, 0, v0
    v_sub_f32 v37, 0, v0
    v_sub_f32 v38, 0, v0
    v_sub_f32 v39, 0, v0
    v_sub_f32 v40, 0, v0
    v_sub_f32 v41, 0, v0
    v_sub_f32 v42, 0, v0
    v_sub_f32 v43, 0, v0
    v_sub_f32 v44, 0, v0
    v_sub_f32 v45, 0, v0
    v_sub_f32 v46, 0, v0
    v_sub_f32 v47, 0, v0
    s_and_b32 s52, s46, 1
    s_mul_i32 s64, s52, 3072
    s_bfe_u32 s52, s46, 0x10001
    s_mul_i32 s52, s52, 122880
    s_add_u32 s64, s64, s52
    s_mul_i32 s52, s63, 61440
    s_add_u32 s64, s64, s52
    s_add_u32 s64, s64, s69
    s_add_u32 s64, s64, 348160
    s_mul_i32 s65, s46, 12288
    s_add_u32 s74, s65, s69
    s_add_u32 s74, s74, 245760
    s_waitcnt lgkmcnt(0)
    ds_read2st64_b64 v[116:119], v4 offset0:0 offset1:4
    v_exp_f32 v80, v80
    v_exp_f32 v81, v81
    v_exp_f32 v82, v82
    v_exp_f32 v83, v83
    v_exp_f32 v84, v84
    v_exp_f32 v85, v85
    v_mfma_f32_32x32x8_bf16 v[96:111], v[10:11], v[28:29], v[32:47]
    ds_read_b64_tr_b16 v[128:129], v6 offset:256
    v_exp_f32 v86, v86
    v_exp_f32 v87, v87
    ds_read_b64_tr_b16 v[130:131], v6 offset:288
    v_exp_f32 v88, v88
    v_exp_f32 v89, v89
    v_mfma_f32_32x32x16_bf16 v[96:111], v[112:115], v[20:23], v[96:111]
    v_exp_f32 v90, v90
    v_exp_f32 v91, v91
    v_exp_f32 v92, v92
    v_exp_f32 v93, v93
    v_smfmac_f32_32x32x32_bf16 v[48:63], v[120:123], v[80:87], v8
    v_exp_f32 v94, v94
    v_exp_f32 v95, v95
    s_waitcnt lgkmcnt(0)
    v_exp_f32 v96, v96
    v_exp_f32 v97, v97
    v_smfmac_f32_32x32x32_bf16 v[48:63], v[124:127], v[88:95], v8
    v_exp_f32 v98, v98
    v_exp_f32 v99, v99
    v_exp_f32 v100, v100
    v_exp_f32 v101, v101
    v_mfma_f32_32x32x8_bf16 v[80:95], v[10:11], v[26:27], v[32:47]
    ds_read_b64_tr_b16 v[132:133], v6 offset:384
    v_exp_f32 v102, v102
    v_exp_f32 v103, v103
    ds_read_b64_tr_b16 v[134:135], v6 offset:416
    v_exp_f32 v104, v104
    v_exp_f32 v105, v105
    v_mfma_f32_32x32x16_bf16 v[80:95], v[116:119], v[16:19], v[80:95]
    v_exp_f32 v106, v106
    v_exp_f32 v107, v107
    v_exp_f32 v108, v108
    v_exp_f32 v109, v109
    v_smfmac_f32_32x32x32_bf16 v[64:79], v[120:123], v[96:103], v8
    v_exp_f32 v110, v110
    v_exp_f32 v111, v111
    s_waitcnt lgkmcnt(0)
    ds_read2st64_b64 v[112:115], v3 offset0:1 offset1:5
    ds_read_b64 v[12:13], v5 offset:512
    v_exp_f32 v80, v80
    v_exp_f32 v81, v81
    v_smfmac_f32_32x32x32_bf16 v[64:79], v[124:127], v[104:111], v8
    v_exp_f32 v82, v82
    v_exp_f32 v83, v83
    v_exp_f32 v84, v84
    v_exp_f32 v85, v85
    v_mfma_f32_32x32x8_bf16 v[96:111], v[10:11], v[30:31], v[32:47]
    ds_read_b64_tr_b16 v[120:121], v6 offset:512
    v_exp_f32 v86, v86
    v_exp_f32 v87, v87
    ds_read_b64_tr_b16 v[122:123], v6 offset:544
    v_exp_f32 v88, v88
    v_exp_f32 v89, v89
    v_mfma_f32_32x32x16_bf16 v[96:111], v[116:119], v[20:23], v[96:111]
    v_exp_f32 v90, v90
    v_exp_f32 v91, v91
    v_exp_f32 v92, v92
    v_exp_f32 v93, v93
    v_smfmac_f32_32x32x32_bf16 v[48:63], v[128:131], v[80:87], v8
    v_exp_f32 v94, v94
    v_exp_f32 v95, v95
    s_waitcnt lgkmcnt(0)
    s_setprio 2
    v_exp_f32 v96, v96
    v_exp_f32 v97, v97
    v_smfmac_f32_32x32x32_bf16 v[48:63], v[132:135], v[88:95], v8
    v_exp_f32 v98, v98
    v_exp_f32 v99, v99
    v_exp_f32 v100, v100
    v_exp_f32 v101, v101
    v_mfma_f32_32x32x8_bf16 v[80:95], v[12:13], v[24:25], v[32:47]
    ds_read_b64_tr_b16 v[124:125], v6 offset:640
    v_exp_f32 v102, v102
    v_exp_f32 v103, v103
    ds_read_b64_tr_b16 v[126:127], v6 offset:672
    v_exp_f32 v104, v104
    v_exp_f32 v105, v105
    v_mfma_f32_32x32x16_bf16 v[80:95], v[112:115], v[16:19], v[80:95]
    v_exp_f32 v106, v106
    v_exp_f32 v107, v107
    v_exp_f32 v108, v108
    v_exp_f32 v109, v109
    v_smfmac_f32_32x32x32_bf16 v[64:79], v[128:131], v[96:103], v8
    v_exp_f32 v110, v110
    v_exp_f32 v111, v111
    s_waitcnt lgkmcnt(0)
    s_setprio 1
    ds_read2st64_b64 v[116:119], v4 offset0:1 offset1:5
    v_exp_f32 v80, v80
    v_exp_f32 v81, v81
    v_smfmac_f32_32x32x32_bf16 v[64:79], v[132:135], v[104:111], v8
    v_exp_f32 v82, v82
    v_exp_f32 v83, v83
    v_exp_f32 v84, v84
    v_exp_f32 v85, v85
    v_mfma_f32_32x32x8_bf16 v[96:111], v[12:13], v[28:29], v[32:47]
    ds_read_b64_tr_b16 v[128:129], v6 offset:768
    v_exp_f32 v86, v86
    v_exp_f32 v87, v87
    ds_read_b64_tr_b16 v[130:131], v6 offset:800
    v_exp_f32 v88, v88
    v_exp_f32 v89, v89
    v_mfma_f32_32x32x16_bf16 v[96:111], v[112:115], v[20:23], v[96:111]
    v_exp_f32 v90, v90
    v_exp_f32 v91, v91
    v_exp_f32 v92, v92
    v_exp_f32 v93, v93
    v_smfmac_f32_32x32x32_bf16 v[48:63], v[120:123], v[80:87], v8
    v_exp_f32 v94, v94
    v_exp_f32 v95, v95
    s_waitcnt lgkmcnt(0)
    s_setprio 0
    v_exp_f32 v96, v96
    v_exp_f32 v97, v97
    v_smfmac_f32_32x32x32_bf16 v[48:63], v[124:127], v[88:95], v8
    v_exp_f32 v98, v98
    v_exp_f32 v99, v99
    v_exp_f32 v100, v100
    v_exp_f32 v101, v101
    v_mfma_f32_32x32x8_bf16 v[80:95], v[12:13], v[26:27], v[32:47]
    ds_read_b64_tr_b16 v[132:133], v6 offset:896
    v_exp_f32 v102, v102
    v_exp_f32 v103, v103
    ds_read_b64_tr_b16 v[134:135], v6 offset:928
    v_exp_f32 v104, v104
    v_exp_f32 v105, v105
    v_mfma_f32_32x32x16_bf16 v[80:95], v[116:119], v[16:19], v[80:95]
    v_exp_f32 v106, v106
    v_exp_f32 v107, v107
    v_exp_f32 v108, v108
    v_exp_f32 v109, v109
    v_smfmac_f32_32x32x32_bf16 v[64:79], v[120:123], v[96:103], v8
    s_waitcnt vmcnt(0)
    s_cmp_eq_u32 s68, 0
    s_cbranch_scc1 Lpp_20
    s_mul_i32 s52, s46, 6144
    s_add_u32 m0, s52, 0
    s_nop 0
    buffer_load_dwordx4 v176, s[84:87], s70 offen lds
    s_add_u32 m0, s52, 1024
    s_nop 0
    buffer_load_dwordx4 v177, s[84:87], s70 offen lds
Lpp_20:
    v_exp_f32 v110, v110
    v_exp_f32 v111, v111
    s_waitcnt lgkmcnt(0)
    s_barrier
    v_add_u32 v3, 0xffff5e00, v3
    v_add_u32 v4, 0xffff5e00, v4
    v_add_u32 v5, 0xffff5e00, v5
    v_and_b32 v0, 0xffff5e00, v7
    v_add_u32 v6, v6, v0
    s_setprio 3
    ds_read2st64_b64 v[112:115], v3 offset0:0 offset1:4
    ds_read_b64 v[10:11], v5 offset:0
    v_exp_f32 v80, v80
    v_exp_f32 v81, v81
    v_smfmac_f32_32x32x32_bf16 v[64:79], v[124:127], v[104:111], v8
    v_exp_f32 v82, v82
    v_exp_f32 v83, v83
    v_exp_f32 v84, v84
    v_exp_f32 v85, v85
    v_mfma_f32_32x32x8_bf16 v[96:111], v[12:13], v[30:31], v[32:47]
    ds_read_b64_tr_b16 v[120:121], v6 offset:0
    v_exp_f32 v86, v86
    v_exp_f32 v87, v87
    ds_read_b64_tr_b16 v[122:123], v6 offset:32
    v_exp_f32 v88, v88
    v_exp_f32 v89, v89
    v_mfma_f32_32x32x16_bf16 v[96:111], v[116:119], v[20:23], v[96:111]
    v_exp_f32 v90, v90
    v_exp_f32 v91, v91
    v_exp_f32 v92, v92
    v_exp_f32 v93, v93
    v_smfmac_f32_32x32x32_bf16 v[48:63], v[128:131], v[80:87], v8
    s_lshl_b32 s52, s61, 11
    s_add_u32 s61, s61, 1
    s_and_b32 s61, s61, 7
    s_add_u32 m0, s58, 120064
    s_add_u32 s53, s55, s52
    buffer_load_dwordx4 v2, s[24:27], s53 offen sc1 lds
    s_add_u32 m0, s59, 120064
    s_add_u32 s53, s56, s52
    buffer_load_dwordx4 v2, s[24:27], s53 offen sc1 lds
    s_cmp_ge_u32 s46, 4
    s_cbranch_scc1 Ld_21
    s_add_u32 m0, s60, 120064
    s_add_u32 s53, s57, s52
    buffer_load_dwordx4 v2, s[24:27], s53 offen sc1 lds
Ld_21:
    v_exp_f32 v94, v94
    v_exp_f32 v95, v95
    s_waitcnt lgkmcnt(0)
    v_exp_f32 v96, v96
    v_exp_f32 v97, v97
    v_smfmac_f32_32x32x32_bf16 v[48:63], v[132:135], v[88:95], v8
    v_exp_f32 v98, v98
    v_exp_f32 v99, v99
    v_exp_f32 v100, v100
    v_exp_f32 v101, v101
    v_mfma_f32_32x32x8_bf16 v[80:95], v[10:11], v[24:25], v[32:47]
    ds_read_b64_tr_b16 v[124:125], v6 offset:128
    v_exp_f32 v102, v102
    v_exp_f32 v103, v103
    ds_read_b64_tr_b16 v[126:127], v6 offset:160
    v_exp_f32 v104, v104
    v_exp_f32 v105, v105
    v_mfma_f32_32x32x16_bf16 v[80:95], v[112:115], v[16:19], v[80:95]
    v_exp_f32 v106, v106
    v_exp_f32 v107, v107
    v_exp_f32 v108, v108
    v_exp_f32 v109, v109
    v_smfmac_f32_32x32x32_bf16 v[64:79], v[128:131], v[96:103], v8
    s_cmp_eq_u32 s68, 0
    s_cbranch_scc1 Lpp_22
    s_mul_i32 s52, s46, 6144
    s_add_u32 m0, s52, 2048
    s_nop 0
    buffer_load_dwordx4 v178, s[84:87], s70 offen lds
    s_add_u32 m0, s52, 3072
    s_nop 0
    buffer_load_dwordx4 v179, s[84:87], s70 offen lds
Lpp_22:
    s_cmp_lg_u32 s46, 6
    s_cbranch_scc1 Lon_23
    v_lshlrev_b32 v14, 7, v1
    s_mov_b64 exec, 0xffffff
    buffer_load_dword v9, v14, s[36:39], 0 offen
    s_mov_b64 exec, 0x3ff
    buffer_load_dword v9, v14, s[40:43], 0 offen
    s_mov_b64 exec, -1
Lon_23:
    v_exp_f32 v110, v110
    v_exp_f32 v111, v111
    s_waitcnt lgkmcnt(0)
    ds_read2st64_b64 v[116:119], v4 offset0:0 offset1:4
    v_exp_f32 v80, v80
    v_exp_f32 v81, v81
    v_smfmac_f32_32x32x32_bf16 v[64:79], v[132:135], v[104:111], v8
    v_exp_f32 v82, v82
    v_exp_f32 v83, v83
    v_exp_f32 v84, v84
    v_exp_f32 v85, v85
    v_mfma_f32_32x32x8_bf16 v[96:111], v[10:11], v[28:29], v[32:47]
    ds_read_b64_tr_b16 v[128:129], v6 offset:256
    v_exp_f32 v86, v86
    v_exp_f32 v87, v87
    ds_read_b64_tr_b16 v[130:131], v6 offset:288
    v_exp_f32 v88, v88
    v_exp_f32 v89, v89
    v_mfma_f32_32x32x16_bf16 v[96:111], v[112:115], v[20:23], v[96:111]
    v_exp_f32 v90, v90
    v_exp_f32 v91, v91
    v_exp_f32 v92, v92
    v_exp_f32 v93, v93
    v_smfmac_f32_32x32x32_bf16 v[48:63], v[120:123], v[80:87], v8
    s_cmp_eq_u32 s68, 0
    s_cbranch_scc1 Lpp_24
    s_mul_i32 s52, s46, 6144
    s_add_u32 m0, s52, 4096
    s_nop 0
    buffer_load_dwordx4 v180, s[84:87], s70 offen lds
    s_add_u32 m0, s52, 5120
    s_nop 0
    buffer_load_dwordx4 v181, s[84:87], s70 offen lds
Lpp_24:
    v_exp_f32 v94, v94
    v_exp_f32 v95, v95
    s_waitcnt lgkmcnt(0)
    v_exp_f32 v96, v96
    v_exp_f32 v97, v97
    v_smfmac_f32_32x32x32_bf16 v[48:63], v[124:127], v[88:95], v8
    v_exp_f32 v98, v98
    v_exp_f32 v99, v99
    v_exp_f32 v100, v100
    v_exp_f32 v101, v101
    v_mfma_f32_32x32x8_bf16 v[80:95], v[10:11], v[26:27], v[32:47]
    ds_read_b64_tr_b16 v[132:133], v6 offset:384
    v_exp_f32 v102, v102
    v_exp_f32 v103, v103
    ds_read_b64_tr_b16 v[134:135], v6 offset:416
    v_exp_f32 v104, v104
    v_exp_f32 v105, v105
    v_mfma_f32_32x32x16_bf16 v[80:95], v[116:119], v[16:19], v[80:95]
    v_exp_f32 v106, v106
    v_exp_f32 v107, v107
    v_exp_f32 v108, v108
    v_exp_f32 v109, v109
    v_smfmac_f32_32x32x32_bf16 v[64:79], v[120:123], v[96:103], v8
    v_exp_f32 v110, v110
    v_exp_f32 v111, v111
    s_waitcnt lgkmcnt(0)
    ds_read2st64_b64 v[112:115], v3 offset0:1 offset1:5
    ds_read_b64 v[12:13], v5 offset:512
    v_exp_f32 v80, v80
    v_exp_f32 v81, v81
    v_smfmac_f32_32x32x32_bf16 v[64:79], v[124:127], v[104:111], v8
    v_exp_f32 v82, v82
    v_exp_f32 v83, v83
    v_exp_f32 v84, v84
    v_exp_f32 v85, v85
    v_mfma_f32_32x32x8_bf16 v[96:111], v[10:11], v[30:31], v[32:47]
    ds_read_b64_tr_b16 v[120:121], v6 offset:512
    v_exp_f32 v86, v86
    v_exp_f32 v87, v87
    ds_read_b64_tr_b16 v[122:123], v6 offset:544
    v_exp_f32 v88, v88
    v_exp_f32 v89, v89
    v_mfma_f32_32x32x16_bf16 v[96:111], v[116:119], v[20:23], v[96:111]
    v_exp_f32 v90, v90
    v_exp_f32 v91, v91
    v_exp_f32 v92, v92
    v_exp_f32 v93, v93
    v_smfmac_f32_32x32x32_bf16 v[48:63], v[128:131], v[80:87], v8
    v_exp_f32 v94, v94
    v_exp_f32 v95, v95
    s_waitcnt lgkmcnt(0)
    s_setprio 2
    v_exp_f32 v96, v96
    v_exp_f32 v97, v97
    v_smfmac_f32_32x32x32_bf16 v[48:63], v[132:135], v[88:95], v8
    v_exp_f32 v98, v98
    v_exp_f32 v99, v99
    v_exp_f32 v100, v100
    v_exp_f32 v101, v101
    v_mfma_f32_32x32x8_bf16 v[80:95], v[12:13], v[24:25], v[32:47]
    ds_read_b64_tr_b16 v[124:125], v6 offset:640
    v_exp_f32 v102, v102
    v_exp_f32 v103, v103
    ds_read_b64_tr_b16 v[126:127], v6 offset:672
    v_exp_f32 v104, v104
    v_exp_f32 v105, v105
    v_mfma_f32_32x32x16_bf16 v[80:95], v[112:115], v[16:19], v[80:95]
    v_exp_f32 v106, v106
    v_exp_f32 v107, v107
    v_exp_f32 v108, v108
    v_exp_f32 v109, v109
    v_smfmac_f32_32x32x32_bf16 v[64:79], v[128:131], v[96:103], v8
    v_exp_f32 v110, v110
    v_exp_f32 v111, v111
    s_waitcnt lgkmcnt(0)
    s_setprio 1
    ds_read2st64_b64 v[116:119], v4 offset0:1 offset1:5
    v_exp_f32 v80, v80
    v_exp_f32 v81, v81
    v_smfmac_f32_32x32x32_bf16 v[64:79], v[132:135], v[104:111], v8
    v_exp_f32 v82, v82
    v_exp_f32 v83, v83
    v_exp_f32 v84, v84
    v_exp_f32 v85, v85
    v_mfma_f32_32x32x8_bf16 v[96:111], v[12:13], v[28:29], v[32:47]
    ds_read_b64_tr_b16 v[128:129], v6 offset:768
    v_exp_f32 v86, v86
    v_exp_f32 v87, v87
    ds_read_b64_tr_b16 v[130:131], v6 offset:800
    v_exp_f32 v88, v88
    v_exp_f32 v89, v89
    v_mfma_f32_32x32x16_bf16 v[96:111], v[112:115], v[20:23], v[96:111]
    v_exp_f32 v90, v90
    v_exp_f32 v91, v91
    v_exp_f32 v92, v92
    v_exp_f32 v93, v93
    v_smfmac_f32_32x32x32_bf16 v[48:63], v[120:123], v[80:87], v8
    v_exp_f32 v94, v94
    v_exp_f32 v95, v95
    s_waitcnt lgkmcnt(0)
    s_setprio 0
    v_exp_f32 v96, v96
    v_exp_f32 v97, v97
    v_smfmac_f32_32x32x32_bf16 v[48:63], v[124:127], v[88:95], v8
    v_exp_f32 v98, v98
    v_exp_f32 v99, v99
    v_exp_f32 v100, v100
    v_exp_f32 v101, v101
    v_mfma_f32_32x32x8_bf16 v[80:95], v[12:13], v[26:27], v[32:47]
    ds_read_b64_tr_b16 v[132:133], v6 offset:896
    v_exp_f32 v102, v102
    v_exp_f32 v103, v103
    ds_read_b64_tr_b16 v[134:135], v6 offset:928
    v_exp_f32 v104, v104
    v_exp_f32 v105, v105
    v_mfma_f32_32x32x16_bf16 v[80:95], v[116:119], v[16:19], v[80:95]
    v_exp_f32 v106, v106
    v_exp_f32 v107, v107
    v_exp_f32 v108, v108
    v_exp_f32 v109, v109
    v_smfmac_f32_32x32x32_bf16 v[64:79], v[120:123], v[96:103], v8
    s_waitcnt vmcnt(0)
    s_cmp_eq_u32 s68, 0
    s_cbranch_scc1 Lpp_25
    ds_read_b64_tr_b16 v[136:137], v9 offset:0
    ds_read_b64_tr_b16 v[138:139], v9 offset:1536
    ds_read_b64_tr_b16 v[140:141], v9 offset:32
    ds_read_b64_tr_b16 v[142:143], v9 offset:1568
Lpp_25:
    v_exp_f32 v110, v110
    v_exp_f32 v111, v111
    s_waitcnt lgkmcnt(0)
    s_barrier
    v_add_u32 v3, 0x5100, v3
    v_add_u32 v4, 0x5100, v4
    v_add_u32 v5, 0x5100, v5
    v_and_b32 v0, 0x5100, v7
    v_add_u32 v6, v6, v0
    s_setprio 3
    ds_read2st64_b64 v[112:115], v3 offset0:0 offset1:4
    ds_read_b64 v[10:11], v5 offset:0
    v_exp_f32 v80, v80
    v_exp_f32 v81, v81
    v_smfmac_f32_32x32x32_bf16 v[64:79], v[124:127], v[104:111], v8
    v_exp_f32 v82, v82
    v_exp_f32 v83, v83
    v_exp_f32 v84, v84
    v_exp_f32 v85, v85
    v_mfma_f32_32x32x8_bf16 v[96:111], v[12:13], v[30:31], v[32:47]
    ds_read_b64_tr_b16 v[120:121], v6 offset:0
    v_exp_f32 v86, v86
    v_exp_f32 v87, v87
    ds_read_b64_tr_b16 v[122:123], v6 offset:32
    v_exp_f32 v88, v88
    v_exp_f32 v89, v89
    v_mfma_f32_32x32x16_bf16 v[96:111], v[116:119], v[20:23], v[96:111]
    v_exp_f32 v90, v90
    v_exp_f32 v91, v91
    v_exp_f32 v92, v92
    v_exp_f32 v93, v93
    v_smfmac_f32_32x32x32_bf16 v[48:63], v[128:131], v[80:87], v8
    s_lshl_b32 s52, s61, 11
    s_add_u32 s61, s61, 1
    s_and_b32 s61, s61, 7
    s_add_u32 m0, s58, 140800
    s_add_u32 s53, s55, s52
    buffer_load_dwordx4 v2, s[24:27], s53 offen sc1 lds
    s_add_u32 m0, s59, 140800
    s_add_u32 s53, s56, s52
    buffer_load_dwordx4 v2, s[24:27], s53 offen sc1 lds
    s_cmp_ge_u32 s46, 4
    s_cbranch_scc1 Ld_26
    s_add_u32 m0, s60, 140800
    s_add_u32 s53, s57, s52
    buffer_load_dwordx4 v2, s[24:27], s53 offen sc1 lds
Ld_26:
    s_cmp_eq_u32 s68, 0
    s_cbranch_scc1 Lpp_27
    ds_read_b64_tr_b16 v[144:145], v9 offset:64
    ds_read_b64_tr_b16 v[146:147], v9 offset:1600
    ds_read_b64_tr_b16 v[148:149], v9 offset:96
    ds_read_b64_tr_b16 v[150:151], v9 offset:1632
Lpp_27:
    v_exp_f32 v94, v94
    v_exp_f32 v95, v95
    s_waitcnt lgkmcnt(0)
    v_exp_f32 v96, v96
    v_exp_f32 v97, v97
    v_smfmac_f32_32x32x32_bf16 v[48:63], v[132:135], v[88:95], v8
    v_exp_f32 v98, v98
    v_exp_f32 v99, v99
    v_exp_f32 v100, v100
    v_exp_f32 v101, v101
    v_mfma_f32_32x32x8_bf16 v[80:95], v[10:11], v[24:25], v[32:47]
    ds_read_b64_tr_b16 v[124:125], v6 offset:128
    v_exp_f32 v102, v102
    v_exp_f32 v103, v103
    ds_read_b64_tr_b16 v[126:127], v6 offset:160
    v_exp_f32 v104, v104
    v_exp_f32 v105, v105
    v_mfma_f32_32x32x16_bf16 v[80:95], v[112:115], v[16:19], v[80:95]
    v_exp_f32 v106, v106
    v_exp_f32 v107, v107
    v_exp_f32 v108, v108
    v_exp_f32 v109, v109
    v_smfmac_f32_32x32x32_bf16 v[64:79], v[128:131], v[96:103], v8
    s_cmp_eq_u32 s68, 0
    s_cbranch_scc1 Lpp_28
    ds_read_b64_tr_b16 v[152:153], v9 offset:128
    ds_read_b64_tr_b16 v[154:155], v9 offset:1664
    ds_read_b64_tr_b16 v[156:157], v9 offset:160
    ds_read_b64_tr_b16 v[158:159], v9 offset:1696
Lpp_28:
    s_cmp_eq_u32 s68, 0
    s_cbranch_scc1 Lpp_29
    buffer_store_dwordx4 v[136:139], v2, s[24:27], s71 offen offset:0 sc1
    buffer_store_dwordx4 v[140:143], v2, s[24:27], s71 offen offset:1024 sc1
Lpp_29:
    v_exp_f32 v110, v110
    v_exp_f32 v111, v111
    s_waitcnt lgkmcnt(0)
    ds_read2st64_b64 v[116:119], v4 offset0:0 offset1:4
    v_exp_f32 v80, v80
    v_exp_f32 v81, v81
    v_smfmac_f32_32x32x32_bf16 v[64:79], v[132:135], v[104:111], v8
    v_exp_f32 v82, v82
    v_exp_f32 v83, v83
    v_exp_f32 v84, v84
    v_exp_f32 v85, v85
    v_mfma_f32_32x32x8_bf16 v[96:111], v[10:11], v[28:29], v[32:47]
    ds_read_b64_tr_b16 v[128:129], v6 offset:256
    v_exp_f32 v86, v86
    v_exp_f32 v87, v87
    ds_read_b64_tr_b16 v[130:131], v6 offset:288
    v_exp_f32 v88, v88
    v_exp_f32 v89, v89
    v_mfma_f32_32x32x16_bf16 v[96:111], v[112:115], v[20:23], v[96:111]
    v_exp_f32 v90, v90
    v_exp_f32 v91, v91
    v_exp_f32 v92, v92
    v_exp_f32 v93, v93
    v_smfmac_f32_32x32x32_bf16 v[48:63], v[120:123], v[80:87], v8
    s_cmp_eq_u32 s68, 0
    s_cbranch_scc1 Lpp_30
    buffer_store_dwordx4 v[144:147], v2, s[24:27], s71 offen offset:2048 sc1
    buffer_store_dwordx4 v[148:151], v2, s[24:27], s71 offen offset:3072 sc1
Lpp_30:
    v_exp_f32 v94, v94
    v_exp_f32 v95, v95
    s_waitcnt lgkmcnt(0)
    v_exp_f32 v96, v96
    v_exp_f32 v97, v97
    v_smfmac_f32_32x32x32_bf16 v[48:63], v[124:127], v[88:95], v8
    v_exp_f32 v98, v98
    v_exp_f32 v99, v99
    v_exp_f32 v100, v100
    v_exp_f32 v101, v101
    v_mfma_f32_32x32x8_bf16 v[80:95], v[10:11], v[26:27], v[32:47]
    ds_read_b64_tr_b16 v[132:133], v6 offset:384
    v_exp_f32 v102, v102
    v_exp_f32 v103, v103
    ds_read_b64_tr_b16 v[134:135], v6 offset:416
    v_exp_f32 v104, v104
    v_exp_f32 v105, v105
    v_mfma_f32_32x32x16_bf16 v[80:95], v[116:119], v[16:19], v[80:95]
    v_exp_f32 v106, v106
    v_exp_f32 v107, v107
    v_exp_f32 v108, v108
    v_exp_f32 v109, v109
    v_smfmac_f32_32x32x32_bf16 v[64:79], v[120:123], v[96:103], v8
    s_cmp_eq_u32 s68, 0
    s_cbranch_scc1 Lpp_31
    s_add_u32 s52, s71, 4096
    buffer_store_dwordx4 v[152:155], v2, s[24:27], s52 offen offset:0 sc1
    s_cmp_eq_u32 s73, 0
    s_cbranch_scc1 Lp6_32
    buffer_store_dwordx4 v[156:159], v2, s[24:27], s52 offen offset:1024 sc1
Lp6_32:
Lpp_31:
    v_exp_f32 v110, v110
    v_exp_f32 v111, v111
    s_waitcnt lgkmcnt(0)
    ds_read2st64_b64 v[112:115], v3 offset0:1 offset1:5
    ds_read_b64 v[12:13], v5 offset:512
    v_exp_f32 v80, v80
    v_exp_f32 v81, v81
    v_smfmac_f32_32x32x32_bf16 v[64:79], v[124:127], v[104:111], v8
    v_exp_f32 v82, v82
    v_exp_f32 v83, v83
    v_exp_f32 v84, v84
    v_exp_f32 v85, v85
    v_mfma_f32_32x32x8_bf16 v[96:111], v[10:11], v[30:31], v[32:47]
    ds_read_b64_tr_b16 v[120:121], v6 offset:512
    v_exp_f32 v86, v86
    v_exp_f32 v87, v87
    ds_read_b64_tr_b16 v[122:123], v6 offset:544
    v_exp_f32 v88, v88
    v_exp_f32 v89, v89
    v_mfma_f32_32x32x16_bf16 v[96:111], v[116:119], v[20:23], v[96:111]
    v_exp_f32 v90, v90
    v_exp_f32 v91, v91
    v_exp_f32 v92, v92
    v_exp_f32 v93, v93
    v_smfmac_f32_32x32x32_bf16 v[48:63], v[128:131], v[80:87], v8
    v_exp_f32 v94, v94
    v_exp_f32 v95, v95
    s_waitcnt lgkmcnt(0)
    s_setprio 2
    v_exp_f32 v96, v96
    v_exp_f32 v97, v97
    v_smfmac_f32_32x32x32_bf16 v[48:63], v[132:135], v[88:95], v8
    v_exp_f32 v98, v98
    v_exp_f32 v99, v99
    v_exp_f32 v100, v100
    v_exp_f32 v101, v101
    v_mfma_f32_32x32x8_bf16 v[80:95], v[12:13], v[24:25], v[32:47]
    ds_read_b64_tr_b16 v[124:125], v6 offset:640
    v_exp_f32 v102, v102
    v_exp_f32 v103, v103
    ds_read_b64_tr_b16 v[126:127], v6 offset:672
    v_exp_f32 v104, v104
    v_exp_f32 v105, v105
    v_mfma_f32_32x32x16_bf16 v[80:95], v[112:115], v[16:19], v[80:95]
    v_exp_f32 v106, v106
    v_exp_f32 v107, v107
    v_exp_f32 v108, v108
    v_exp_f32 v109, v109
    v_smfmac_f32_32x32x32_bf16 v[64:79], v[128:131], v[96:103], v8
    v_exp_f32 v110, v110
    v_exp_f32 v111, v111
    s_waitcnt lgkmcnt(0)
    s_setprio 1
    ds_read2st64_b64 v[116:119], v4 offset0:1 offset1:5
    v_exp_f32 v80, v80
    v_exp_f32 v81, v81
    v_smfmac_f32_32x32x32_bf16 v[64:79], v[132:135], v[104:111], v8
    v_exp_f32 v82, v82
    v_exp_f32 v83, v83
    v_exp_f32 v84, v84
    v_exp_f32 v85, v85
    v_mfma_f32_32x32x8_bf16 v[96:111], v[12:13], v[28:29], v[32:47]
    ds_read_b64_tr_b16 v[128:129], v6 offset:768
    v_exp_f32 v86, v86
    v_exp_f32 v87, v87
    ds_read_b64_tr_b16 v[130:131], v6 offset:800
    v_exp_f32 v88, v88
    v_exp_f32 v89, v89
    v_mfma_f32_32x32x16_bf16 v[96:111], v[112:115], v[20:23], v[96:111]
    v_exp_f32 v90, v90
    v_exp_f32 v91, v91
    v_exp_f32 v92, v92
    v_exp_f32 v93, v93
    v_smfmac_f32_32x32x32_bf16 v[48:63], v[120:123], v[80:87], v8
    v_exp_f32 v94, v94
    v_exp_f32 v95, v95
    s_waitcnt lgkmcnt(0)
    s_setprio 0
    v_exp_f32 v96, v96
    v_exp_f32 v97, v97
    v_smfmac_f32_32x32x32_bf16 v[48:63], v[124:127], v[88:95], v8
    v_exp_f32 v98, v98
    v_exp_f32 v99, v99
    v_exp_f32 v100, v100
    v_exp_f32 v101, v101
    v_mfma_f32_32x32x8_bf16 v[80:95], v[12:13], v[26:27], v[32:47]
    ds_read_b64_tr_b16 v[132:133], v6 offset:896
    v_exp_f32 v102, v102
    v_exp_f32 v103, v103
    ds_read_b64_tr_b16 v[134:135], v6 offset:928
    v_exp_f32 v104, v104
    v_exp_f32 v105, v105
    v_mfma_f32_32x32x16_bf16 v[80:95], v[116:119], v[16:19], v[80:95]
    v_exp_f32 v106, v106
    v_exp_f32 v107, v107
    v_exp_f32 v108, v108
    v_exp_f32 v109, v109
    v_smfmac_f32_32x32x32_bf16 v[64:79], v[120:123], v[96:103], v8
    s_waitcnt vmcnt(0)
    s_cmp_eq_u32 s68, 0
    s_cbranch_scc1 Lpp_33
    v_mov_b32 v176, s48
    v_mov_b32 v177, s49
    v_mov_b32 v178, 0
    s_mov_b64 exec, 1
    buffer_store_dwordx2 v[176:177], v178, s[24:27], s72 offen sc1
    s_mov_b64 exec, -1
Lpp_33:
    v_exp_f32 v110, v110
    v_exp_f32 v111, v111
    s_waitcnt lgkmcnt(0)
    s_barrier
    v_add_u32 v3, 0x5100, v3
    v_add_u32 v4, 0x5100, v4
    v_add_u32 v5, 0x5100, v5
    v_and_b32 v0, 0x5100, v7
    v_add_u32 v6, v6, v0
    s_setprio 3
    ds_read2st64_b64 v[112:115], v3 offset0:0 offset1:4
    ds_read_b64 v[10:11], v5 offset:0
    v_exp_f32 v80, v80
    v_exp_f32 v81, v81
    v_smfmac_f32_32x32x32_bf16 v[64:79], v[124:127], v[104:111], v8
    v_exp_f32 v82, v82
    v_exp_f32 v83, v83
    v_exp_f32 v84, v84
    v_exp_f32 v85, v85
    v_mfma_f32_32x32x8_bf16 v[96:111], v[12:13], v[30:31], v[32:47]
    ds_read_b64_tr_b16 v[120:121], v6 offset:0
    v_exp_f32 v86, v86
    v_exp_f32 v87, v87
    ds_read_b64_tr_b16 v[122:123], v6 offset:32
    v_exp_f32 v88, v88
    v_exp_f32 v89, v89
    v_mfma_f32_32x32x16_bf16 v[96:111], v[116:119], v[20:23], v[96:111]
    v_exp_f32 v90, v90
    v_exp_f32 v91, v91
    v_exp_f32 v92, v92
    v_exp_f32 v93, v93
    v_smfmac_f32_32x32x32_bf16 v[48:63], v[128:131], v[80:87], v8
    s_lshl_b32 s52, s61, 11
    s_add_u32 s61, s61, 1
    s_and_b32 s61, s61, 7
    s_add_u32 m0, s58, 99328
    s_add_u32 s53, s55, s52
    buffer_load_dwordx4 v2, s[24:27], s53 offen sc1 lds
    s_add_u32 m0, s59, 99328
    s_add_u32 s53, s56, s52
    buffer_load_dwordx4 v2, s[24:27], s53 offen sc1 lds
    s_cmp_ge_u32 s46, 4
    s_cbranch_scc1 Ld_34
    s_add_u32 m0, s60, 99328
    s_add_u32 s53, s57, s52
    buffer_load_dwordx4 v2, s[24:27], s53 offen sc1 lds
Ld_34:
    v_exp_f32 v94, v94
    v_exp_f32 v95, v95
    s_waitcnt lgkmcnt(0)
    v_exp_f32 v96, v96
    v_exp_f32 v97, v97
    v_smfmac_f32_32x32x32_bf16 v[48:63], v[132:135], v[88:95], v8
    v_exp_f32 v98, v98
    v_exp_f32 v99, v99
    v_exp_f32 v100, v100
    v_exp_f32 v101, v101
    v_mfma_f32_32x32x8_bf16 v[80:95], v[10:11], v[24:25], v[32:47]
    ds_read_b64_tr_b16 v[124:125], v6 offset:128
    v_exp_f32 v102, v102
    v_exp_f32 v103, v103
    ds_read_b64_tr_b16 v[126:127], v6 offset:160
    v_exp_f32 v104, v104
    v_exp_f32 v105, v105
    v_mfma_f32_32x32x16_bf16 v[80:95], v[112:115], v[16:19], v[80:95]
    v_exp_f32 v106, v106
    v_exp_f32 v107, v107
    v_exp_f32 v108, v108
    v_exp_f32 v109, v109
    v_smfmac_f32_32x32x32_bf16 v[64:79], v[128:131], v[96:103], v8
    v_exp_f32 v110, v110
    v_exp_f32 v111, v111
    s_waitcnt lgkmcnt(0)
    ds_read2st64_b64 v[116:119], v4 offset0:0 offset1:4
    v_exp_f32 v80, v80
    v_exp_f32 v81, v81
    v_smfmac_f32_32x32x32_bf16 v[64:79], v[132:135], v[104:111], v8
    v_exp_f32 v82, v82
    v_exp_f32 v83, v83
    v_exp_f32 v84, v84
    v_exp_f32 v85, v85
    v_mfma_f32_32x32x8_bf16 v[96:111], v[10:11], v[28:29], v[32:47]
    ds_read_b64_tr_b16 v[128:129], v6 offset:256
    v_exp_f32 v86, v86
    v_exp_f32 v87, v87
    ds_read_b64_tr_b16 v[130:131], v6 offset:288
    v_exp_f32 v88, v88
    v_exp_f32 v89, v89
    v_mfma_f32_32x32x16_bf16 v[96:111], v[112:115], v[20:23], v[96:111]
    v_exp_f32 v90, v90
    v_exp_f32 v91, v91
    v_exp_f32 v92, v92
    v_exp_f32 v93, v93
    v_smfmac_f32_32x32x32_bf16 v[48:63], v[120:123], v[80:87], v8
    v_exp_f32 v94, v94
    v_exp_f32 v95, v95
    s_waitcnt lgkmcnt(0)
    v_exp_f32 v96, v96
    v_exp_f32 v97, v97
    v_smfmac_f32_32x32x32_bf16 v[48:63], v[124:127], v[88:95], v8
    v_exp_f32 v98, v98
    v_exp_f32 v99, v99
    v_exp_f32 v100, v100
    v_exp_f32 v101, v101
    v_mfma_f32_32x32x8_bf16 v[80:95], v[10:11], v[26:27], v[32:47]
    ds_read_b64_tr_b16 v[132:133], v6 offset:384
    v_exp_f32 v102, v102
    v_exp_f32 v103, v103
    ds_read_b64_tr_b16 v[134:135], v6 offset:416
    v_exp_f32 v104, v104
    v_exp_f32 v105, v105
    v_mfma_f32_32x32x16_bf16 v[80:95], v[116:119], v[16:19], v[80:95]
    v_exp_f32 v106, v106
    v_exp_f32 v107, v107
    v_exp_f32 v108, v108
    v_exp_f32 v109, v109
    v_smfmac_f32_32x32x32_bf16 v[64:79], v[120:123], v[96:103], v8
    v_exp_f32 v110, v110
    v_exp_f32 v111, v111
    s_waitcnt lgkmcnt(0)
    ds_read2st64_b64 v[112:115], v3 offset0:1 offset1:5
    ds_read_b64 v[12:13], v5 offset:512
    v_exp_f32 v80, v80
    v_exp_f32 v81, v81
    v_smfmac_f32_32x32x32_bf16 v[64:79], v[124:127], v[104:111], v8
    v_exp_f32 v82, v82
    v_exp_f32 v83, v83
    v_exp_f32 v84, v84
    v_exp_f32 v85, v85
    v_mfma_f32_32x32x8_bf16 v[96:111], v[10:11], v[30:31], v[32:47]
    ds_read_b64_tr_b16 v[120:121], v6 offset:512
    v_exp_f32 v86, v86
    v_exp_f32 v87, v87
    ds_read_b64_tr_b16 v[122:123], v6 offset:544
    v_exp_f32 v88, v88
    v_exp_f32 v89, v89
    v_mfma_f32_32x32x16_bf16 v[96:111], v[116:119], v[20:23], v[96:111]
    v_exp_f32 v90, v90
    v_exp_f32 v91, v91
    v_exp_f32 v92, v92
    v_exp_f32 v93, v93
    v_smfmac_f32_32x32x32_bf16 v[48:63], v[128:131], v[80:87], v8
    v_exp_f32 v94, v94
    v_exp_f32 v95, v95
    s_waitcnt lgkmcnt(0)
    s_setprio 2
    v_exp_f32 v96, v96
    v_exp_f32 v97, v97
    v_smfmac_f32_32x32x32_bf16 v[48:63], v[132:135], v[88:95], v8
    v_exp_f32 v98, v98
    v_exp_f32 v99, v99
    v_exp_f32 v100, v100
    v_exp_f32 v101, v101
    v_mfma_f32_32x32x8_bf16 v[80:95], v[12:13], v[24:25], v[32:47]
    ds_read_b64_tr_b16 v[124:125], v6 offset:640
    v_exp_f32 v102, v102
    v_exp_f32 v103, v103
    ds_read_b64_tr_b16 v[126:127], v6 offset:672
    v_exp_f32 v104, v104
    v_exp_f32 v105, v105
    v_mfma_f32_32x32x16_bf16 v[80:95], v[112:115], v[16:19], v[80:95]
    v_exp_f32 v106, v106
    v_exp_f32 v107, v107
    v_exp_f32 v108, v108
    v_exp_f32 v109, v109
    v_smfmac_f32_32x32x32_bf16 v[64:79], v[128:131], v[96:103], v8
    s_cmp_lg_u32 s46, 7
    s_cbranch_scc1 Lpq_35
    s_lshl_b32 s72, s51, 10
    s_add_u32 s72, s72, 20987904
    v_min_u32 v220, 848, v2
    buffer_load_dwordx4 v[216:219], v220, s[24:27], s72 offen sc1
Lpq_35:
    v_exp_f32 v110, v110
    v_exp_f32 v111, v111
    s_waitcnt lgkmcnt(0)
    s_setprio 1
    ds_read2st64_b64 v[116:119], v4 offset0:1 offset1:5
    v_exp_f32 v80, v80
    v_exp_f32 v81, v81
    v_smfmac_f32_32x32x32_bf16 v[64:79], v[132:135], v[104:111], v8
    v_exp_f32 v82, v82
    v_exp_f32 v83, v83
    v_exp_f32 v84, v84
    v_exp_f32 v85, v85
    v_mfma_f32_32x32x8_bf16 v[96:111], v[12:13], v[28:29], v[32:47]
    ds_read_b64_tr_b16 v[128:129], v6 offset:768
    v_exp_f32 v86, v86
    v_exp_f32 v87, v87
    ds_read_b64_tr_b16 v[130:131], v6 offset:800
    v_exp_f32 v88, v88
    v_exp_f32 v89, v89
    v_mfma_f32_32x32x16_bf16 v[96:111], v[112:115], v[20:23], v[96:111]
    v_exp_f32 v90, v90
    v_exp_f32 v91, v91
    v_exp_f32 v92, v92
    v_exp_f32 v93, v93
    v_smfmac_f32_32x32x32_bf16 v[48:63], v[120:123], v[80:87], v8
    v_exp_f32 v94, v94
    v_exp_f32 v95, v95
    s_waitcnt lgkmcnt(0)
    s_setprio 0
    v_exp_f32 v96, v96
    v_exp_f32 v97, v97
    v_smfmac_f32_32x32x32_bf16 v[48:63], v[124:127], v[88:95], v8
    v_exp_f32 v98, v98
    v_exp_f32 v99, v99
    v_exp_f32 v100, v100
    v_exp_f32 v101, v101
    v_mfma_f32_32x32x8_bf16 v[80:95], v[12:13], v[26:27], v[32:47]
    ds_read_b64_tr_b16 v[132:133], v6 offset:896
    v_exp_f32 v102, v102
    v_exp_f32 v103, v103
    ds_read_b64_tr_b16 v[134:135], v6 offset:928
    v_exp_f32 v104, v104
    v_exp_f32 v105, v105
    v_mfma_f32_32x32x16_bf16 v[80:95], v[116:119], v[16:19], v[80:95]
    v_exp_f32 v106, v106
    v_exp_f32 v107, v107
    v_exp_f32 v108, v108
    v_exp_f32 v109, v109
    v_smfmac_f32_32x32x32_bf16 v[64:79], v[120:123], v[96:103], v8
    s_waitcnt vmcnt(0)
    s_cmp_lg_u32 s46, 7
    s_cbranch_scc1 Lpce_37
    s_mov_b32 s94, 0
Lpc_36:
    s_waitcnt vmcnt(0)
    v_cmp_ne_u64 vcc, s[48:49], v[216:217]
    v_cmp_ne_u64 s[80:81], s[48:49], v[218:219]
    s_nop 0
    s_or_b64 vcc, vcc, s[80:81]
    s_cbranch_vccz Lpce_37
    s_add_u32 s94, s94, 1
    s_cmp_gt_u32 s94, 0x40000
    s_cbranch_scc1 Lpce_37
    v_min_u32 v220, 848, v2
    buffer_load_dwordx4 v[216:219], v220, s[24:27], s72 offen sc1
    s_branch Lpc_36
Lpce_37:
    v_exp_f32 v110, v110
    v_exp_f32 v111, v111
    s_waitcnt lgkmcnt(0)
    s_barrier
    v_add_u32 v3, 0xffff5e00, v3
    v_add_u32 v4, 0xffff5e00, v4
    v_add_u32 v5, 0xffff5e00, v5
    v_and_b32 v0, 0xffff5e00, v7
    v_add_u32 v6, v6, v0
    s_setprio 3
    ds_read2st64_b64 v[112:115], v3 offset0:0 offset1:4
    ds_read_b64 v[10:11], v5 offset:0
    v_exp_f32 v80, v80
    v_exp_f32 v81, v81
    v_smfmac_f32_32x32x32_bf16 v[64:79], v[124:127], v[104:111], v8
    v_exp_f32 v82, v82
    v_exp_f32 v83, v83
    v_exp_f32 v84, v84
    v_exp_f32 v85, v85
    v_mfma_f32_32x32x8_bf16 v[96:111], v[12:13], v[30:31], v[32:47]
    ds_read_b64_tr_b16 v[120:121], v6 offset:0
    v_exp_f32 v86, v86
    v_exp_f32 v87, v87
    ds_read_b64_tr_b16 v[122:123], v6 offset:32
    v_exp_f32 v88, v88
    v_exp_f32 v89, v89
    v_mfma_f32_32x32x16_bf16 v[96:111], v[116:119], v[20:23], v[96:111]
    v_exp_f32 v90, v90
    v_exp_f32 v91, v91
    v_exp_f32 v92, v92
    v_exp_f32 v93, v93
    v_smfmac_f32_32x32x32_bf16 v[48:63], v[128:131], v[80:87], v8
    s_lshl_b32 s52, s61, 11
    s_add_u32 s61, s61, 1
    s_and_b32 s61, s61, 7
    s_add_u32 m0, s58, 120064
    s_add_u32 s53, s55, s52
    buffer_load_dwordx4 v2, s[24:27], s53 offen sc1 lds
    s_add_u32 m0, s59, 120064
    s_add_u32 s53, s56, s52
    buffer_load_dwordx4 v2, s[24:27], s53 offen sc1 lds
    s_cmp_ge_u32 s46, 4
    s_cbranch_scc1 Ld_38
    s_add_u32 m0, s60, 120064
    s_add_u32 s53, s57, s52
    buffer_load_dwordx4 v2, s[24:27], s53 offen sc1 lds
Ld_38:
    v_exp_f32 v94, v94
    v_exp_f32 v95, v95
    s_waitcnt lgkmcnt(0)
    v_exp_f32 v96, v96
    v_exp_f32 v97, v97
    v_smfmac_f32_32x32x32_bf16 v[48:63], v[132:135], v[88:95], v8
    s_add_u32 m0, s65, 0
    s_nop 0
    buffer_load_dwordx4 v2, s[24:27], s74 offen offset:0 sc1 lds
    v_exp_f32 v98, v98
    v_exp_f32 v99, v99
    v_exp_f32 v100, v100
    v_exp_f32 v101, v101
    v_mfma_f32_32x32x8_bf16 v[80:95], v[10:11], v[24:25], v[32:47]
    ds_read_b64_tr_b16 v[124:125], v6 offset:128
    v_exp_f32 v102, v102
    v_exp_f32 v103, v103
    ds_read_b64_tr_b16 v[126:127], v6 offset:160
    v_exp_f32 v104, v104
    v_exp_f32 v105, v105
    v_mfma_f32_32x32x16_bf16 v[80:95], v[112:115], v[16:19], v[80:95]
    s_add_u32 m0, s65, 0
    s_nop 0
    buffer_load_dwordx4 v2, s[24:27], s74 offen offset:1024 sc1 lds
    v_exp_f32 v106, v106
    v_exp_f32 v107, v107
    v_exp_f32 v108, v108
    v_exp_f32 v109, v109
    v_smfmac_f32_32x32x32_bf16 v[64:79], v[128:131], v[96:103], v8
    v_exp_f32 v110, v110
    v_exp_f32 v111, v111
    s_waitcnt lgkmcnt(0)
    ds_read2st64_b64 v[116:119], v4 offset0:0 offset1:4
    v_exp_f32 v80, v80
    v_exp_f32 v81, v81
    v_smfmac_f32_32x32x32_bf16 v[64:79], v[132:135], v[104:111], v8
    s_add_u32 m0, s65, 0
    s_nop 0
    buffer_load_dwordx4 v2, s[24:27], s74 offen offset:2048 sc1 lds
    v_exp_f32 v82, v82
    v_exp_f32 v83, v83
    v_exp_f32 v84, v84
    v_exp_f32 v85, v85
    v_mfma_f32_32x32x8_bf16 v[96:111], v[10:11], v[28:29], v[32:47]
    ds_read_b64_tr_b16 v[128:129], v6 offset:256
    v_exp_f32 v86, v86
    v_exp_f32 v87, v87
    ds_read_b64_tr_b16 v[130:131], v6 offset:288
    v_exp_f32 v88, v88
    v_exp_f32 v89, v89
    v_mfma_f32_32x32x16_bf16 v[96:111], v[112:115], v[20:23], v[96:111]
    s_add_u32 m0, s65, 0
    s_nop 0
    buffer_load_dwordx4 v2, s[24:27], s74 offen offset:3072 sc1 lds
    v_exp_f32 v90, v90
    v_exp_f32 v91, v91
    v_exp_f32 v92, v92
    v_exp_f32 v93, v93
    v_smfmac_f32_32x32x32_bf16 v[48:63], v[120:123], v[80:87], v8
    v_exp_f32 v94, v94
    v_exp_f32 v95, v95
    s_waitcnt lgkmcnt(0)
    v_exp_f32 v96, v96
    v_exp_f32 v97, v97
    v_smfmac_f32_32x32x32_bf16 v[48:63], v[124:127], v[88:95], v8
    v_exp_f32 v98, v98
    v_exp_f32 v99, v99
    v_exp_f32 v100, v100
    v_exp_f32 v101, v101
    v_mfma_f32_32x32x8_bf16 v[80:95], v[10:11], v[26:27], v[32:47]
    ds_read_b64_tr_b16 v[132:133], v6 offset:384
    v_exp_f32 v102, v102
    v_exp_f32 v103, v103
    ds_read_b64_tr_b16 v[134:135], v6 offset:416
    v_exp_f32 v104, v104
    v_exp_f32 v105, v105
    v_mfma_f32_32x32x16_bf16 v[80:95], v[116:119], v[16:19], v[80:95]
    s_add_u32 m0, s65, 4096
    s_add_u32 s74, s74, 4096
    buffer_load_dwordx4 v2, s[24:27], s74 offen offset:0 sc1 lds
    v_exp_f32 v106, v106
    v_exp_f32 v107, v107
    v_exp_f32 v108, v108
    v_exp_f32 v109, v109
    v_smfmac_f32_32x32x32_bf16 v[64:79], v[120:123], v[96:103], v8
    v_exp_f32 v110, v110
    v_exp_f32 v111, v111
    s_waitcnt lgkmcnt(0)
    ds_read2st64_b64 v[112:115], v3 offset0:1 offset1:5
    ds_read_b64 v[12:13], v5 offset:512
    v_exp_f32 v80, v80
    v_exp_f32 v81, v81
    v_smfmac_f32_32x32x32_bf16 v[64:79], v[124:127], v[104:111], v8
    s_add_u32 m0, s65, 4096
    s_nop 0
    buffer_load_dwordx4 v2, s[24:27], s74 offen offset:1024 sc1 lds
    v_exp_f32 v82, v82
    v_exp_f32 v83, v83
    v_exp_f32 v84, v84
    v_exp_f32 v85, v85
    v_mfma_f32_32x32x8_bf16 v[96:111], v[10:11], v[30:31], v[32:47]
    ds_read_b64_tr_b16 v[120:121], v6 offset:512
    v_exp_f32 v86, v86
    v_exp_f32 v87, v87
    ds_read_b64_tr_b16 v[122:123], v6 offset:544
    v_exp_f32 v88, v88
    v_exp_f32 v89, v89
    v_mfma_f32_32x32x16_bf16 v[96:111], v[116:119], v[20:23], v[96:111]
    s_add_u32 m0, s65, 4096
    s_nop 0
    buffer_load_dwordx4 v2, s[24:27], s74 offen offset:2048 sc1 lds
    v_exp_f32 v90, v90
    v_exp_f32 v91, v91
    v_exp_f32 v92, v92
    v_exp_f32 v93, v93
    v_smfmac_f32_32x32x32_bf16 v[48:63], v[128:131], v[80:87], v8
    v_exp_f32 v94, v94
    v_exp_f32 v95, v95
    s_waitcnt lgkmcnt(0)
    s_setprio 2
    v_exp_f32 v96, v96
    v_exp_f32 v97, v97
    v_smfmac_f32_32x32x32_bf16 v[48:63], v[132:135], v[88:95], v8
    s_add_u32 m0, s65, 4096
    s_nop 0
    buffer_load_dwordx4 v2, s[24:27], s74 offen offset:3072 sc1 lds
    v_exp_f32 v98, v98
    v_exp_f32 v99, v99
    v_exp_f32 v100, v100
    v_exp_f32 v101, v101
    v_mfma_f32_32x32x8_bf16 v[80:95], v[12:13], v[24:25], v[32:47]
    ds_read_b64_tr_b16 v[124:125], v6 offset:640
    v_exp_f32 v102, v102
    v_exp_f32 v103, v103
    ds_read_b64_tr_b16 v[126:127], v6 offset:672
    v_exp_f32 v104, v104
    v_exp_f32 v105, v105
    v_mfma_f32_32x32x16_bf16 v[80:95], v[112:115], v[16:19], v[80:95]
    s_add_u32 m0, s65, 8192
    s_add_u32 s74, s74, 4096
    buffer_load_dwordx4 v2, s[24:27], s74 offen offset:0 sc1 lds
    v_exp_f32 v106, v106
    v_exp_f32 v107, v107
    v_exp_f32 v108, v108
    v_exp_f32 v109, v109
    v_smfmac_f32_32x32x32_bf16 v[64:79], v[128:131], v[96:103], v8
    v_exp_f32 v110, v110
    v_exp_f32 v111, v111
    s_waitcnt lgkmcnt(0)
    s_setprio 1
    ds_read2st64_b64 v[116:119], v4 offset0:1 offset1:5
    v_exp_f32 v80, v80
    v_exp_f32 v81, v81
    v_smfmac_f32_32x32x32_bf16 v[64:79], v[132:135], v[104:111], v8
    v_exp_f32 v82, v82
    v_exp_f32 v83, v83
    v_exp_f32 v84, v84
    v_exp_f32 v85, v85
    v_mfma_f32_32x32x8_bf16 v[96:111], v[12:13], v[28:29], v[32:47]
    ds_read_b64_tr_b16 v[128:129], v6 offset:768
    v_exp_f32 v86, v86
    v_exp_f32 v87, v87
    ds_read_b64_tr_b16 v[130:131], v6 offset:800
    v_exp_f32 v88, v88
    v_exp_f32 v89, v89
    v_mfma_f32_32x32x16_bf16 v[96:111], v[112:115], v[20:23], v[96:111]
    s_add_u32 m0, s65, 8192
    s_nop 0
    buffer_load_dwordx4 v2, s[24:27], s74 offen offset:1024 sc1 lds
    v_exp_f32 v90, v90
    v_exp_f32 v91, v91
    v_exp_f32 v92, v92
    v_exp_f32 v93, v93
    v_smfmac_f32_32x32x32_bf16 v[48:63], v[120:123], v[80:87], v8
    v_exp_f32 v94, v94
    v_exp_f32 v95, v95
    s_waitcnt lgkmcnt(0)
    s_setprio 0
    v_exp_f32 v96, v96
    v_exp_f32 v97, v97
    v_smfmac_f32_32x32x32_bf16 v[48:63], v[124:127], v[88:95], v8
    s_add_u32 m0, s65, 8192
    s_nop 0
    buffer_load_dwordx4 v2, s[24:27], s74 offen offset:2048 sc1 lds
    v_exp_f32 v98, v98
    v_exp_f32 v99, v99
    v_exp_f32 v100, v100
    v_exp_f32 v101, v101
    v_mfma_f32_32x32x8_bf16 v[80:95], v[12:13], v[26:27], v[32:47]
    ds_read_b64_tr_b16 v[132:133], v6 offset:896
    v_exp_f32 v102, v102
    v_exp_f32 v103, v103
    ds_read_b64_tr_b16 v[134:135], v6 offset:928
    v_exp_f32 v104, v104
    v_exp_f32 v105, v105
    v_mfma_f32_32x32x16_bf16 v[80:95], v[116:119], v[16:19], v[80:95]
    s_add_u32 m0, s65, 8192
    s_nop 0
    buffer_load_dwordx4 v2, s[24:27], s74 offen offset:3072 sc1 lds
    v_exp_f32 v106, v106
    v_exp_f32 v107, v107
    v_exp_f32 v108, v108
    v_exp_f32 v109, v109
    v_smfmac_f32_32x32x32_bf16 v[64:79], v[120:123], v[96:103], v8
    s_waitcnt vmcnt(12)
    v_exp_f32 v110, v110
    v_exp_f32 v111, v111
    s_waitcnt lgkmcnt(0)
    s_barrier
    v_add_u32 v3, 0x5100, v3
    v_add_u32 v4, 0x5100, v4
    v_add_u32 v5, 0x5100, v5
    v_and_b32 v0, 0x5100, v7
    v_add_u32 v6, v6, v0
    s_setprio 3
    ds_read2st64_b64 v[112:115], v3 offset0:0 offset1:4
    ds_read_b64 v[10:11], v5 offset:0
    v_exp_f32 v80, v80
    v_exp_f32 v81, v81
    v_smfmac_f32_32x32x32_bf16 v[64:79], v[124:127], v[104:111], v8
    v_exp_f32 v82, v82
    v_exp_f32 v83, v83
    v_exp_f32 v84, v84
    v_exp_f32 v85, v85
    v_mfma_f32_32x32x8_bf16 v[96:111], v[12:13], v[30:31], v[32:47]
    ds_read_b64_tr_b16 v[120:121], v6 offset:0
    v_exp_f32 v86, v86
    v_exp_f32 v87, v87
    ds_read_b64_tr_b16 v[122:123], v6 offset:32
    v_exp_f32 v88, v88
    v_exp_f32 v89, v89
    v_mfma_f32_32x32x16_bf16 v[96:111], v[116:119], v[20:23], v[96:111]
    v_exp_f32 v90, v90
    v_exp_f32 v91, v91
    v_exp_f32 v92, v92
    v_exp_f32 v93, v93
    v_smfmac_f32_32x32x32_bf16 v[48:63], v[128:131], v[80:87], v8
    s_lshl_b32 s52, s61, 11
    s_add_u32 s61, s61, 1
    s_and_b32 s61, s61, 7
    s_add_u32 m0, s58, 140800
    s_add_u32 s53, s55, s52
    buffer_load_dwordx4 v2, s[24:27], s53 offen sc1 lds
    s_add_u32 m0, s59, 140800
    s_add_u32 s53, s56, s52
    buffer_load_dwordx4 v2, s[24:27], s53 offen sc1 lds
    s_cmp_ge_u32 s46, 4
    s_cbranch_scc1 Ld_39
    s_add_u32 m0, s60, 140800
    s_add_u32 s53, s57, s52
    buffer_load_dwordx4 v2, s[24:27], s53 offen sc1 lds
Ld_39:
    v_exp_f32 v94, v94
    v_exp_f32 v95, v95
    s_waitcnt lgkmcnt(0)
    v_exp_f32 v96, v96
    v_exp_f32 v97, v97
    v_smfmac_f32_32x32x32_bf16 v[48:63], v[132:135], v[88:95], v8
    buffer_load_dwordx4 v[136:139], v2, s[24:27], s64 offen offset:0 sc1
    v_exp_f32 v98, v98
    v_exp_f32 v99, v99
    v_exp_f32 v100, v100
    v_exp_f32 v101, v101
    v_mfma_f32_32x32x8_bf16 v[80:95], v[10:11], v[24:25], v[32:47]
    ds_read_b64_tr_b16 v[124:125], v6 offset:128
    v_exp_f32 v102, v102
    v_exp_f32 v103, v103
    ds_read_b64_tr_b16 v[126:127], v6 offset:160
    v_exp_f32 v104, v104
    v_exp_f32 v105, v105
    v_mfma_f32_32x32x16_bf16 v[80:95], v[112:115], v[16:19], v[80:95]
    buffer_load_dwordx4 v[176:179], v2, s[24:27], s64 offen offset:1024 sc1
    v_exp_f32 v106, v106
    v_exp_f32 v107, v107
    v_exp_f32 v108, v108
    v_exp_f32 v109, v109
    v_smfmac_f32_32x32x32_bf16 v[64:79], v[128:131], v[96:103], v8
    v_exp_f32 v110, v110
    v_exp_f32 v111, v111
    s_waitcnt lgkmcnt(0)
    ds_read2st64_b64 v[116:119], v4 offset0:0 offset1:4
    v_exp_f32 v80, v80
    v_exp_f32 v81, v81
    v_smfmac_f32_32x32x32_bf16 v[64:79], v[132:135], v[104:111], v8
    v_exp_f32 v82, v82
    v_exp_f32 v83, v83
    v_exp_f32 v84, v84
    v_exp_f32 v85, v85
    v_mfma_f32_32x32x8_bf16 v[96:111], v[10:11], v[28:29], v[32:47]
    ds_read_b64_tr_b16 v[128:129], v6 offset:256
    v_exp_f32 v86, v86
    v_exp_f32 v87, v87
    ds_read_b64_tr_b16 v[130:131], v6 offset:288
    v_exp_f32 v88, v88
    v_exp_f32 v89, v89
    v_mfma_f32_32x32x16_bf16 v[96:111], v[112:115], v[20:23], v[96:111]
    buffer_load_dwordx4 v[216:219], v2, s[24:27], s64 offen offset:2048 sc1
    s_add_u32 s64, s64, 6144
    v_exp_f32 v90, v90
    v_exp_f32 v91, v91
    v_exp_f32 v92, v92
    v_exp_f32 v93, v93
    v_smfmac_f32_32x32x32_bf16 v[48:63], v[120:123], v[80:87], v8
    v_exp_f32 v94, v94
    v_exp_f32 v95, v95
    s_waitcnt lgkmcnt(0)
    v_exp_f32 v96, v96
    v_exp_f32 v97, v97
    v_smfmac_f32_32x32x32_bf16 v[48:63], v[124:127], v[88:95], v8
    buffer_load_dwordx4 v[140:143], v2, s[24:27], s64 offen offset:0 sc1
    v_exp_f32 v98, v98
    v_exp_f32 v99, v99
    v_exp_f32 v100, v100
    v_exp_f32 v101, v101
    v_mfma_f32_32x32x8_bf16 v[80:95], v[10:11], v[26:27], v[32:47]
    ds_read_b64_tr_b16 v[132:133], v6 offset:384
    v_exp_f32 v102, v102
    v_exp_f32 v103, v103
    ds_read_b64_tr_b16 v[134:135], v6 offset:416
    v_exp_f32 v104, v104
    v_exp_f32 v105, v105
    v_mfma_f32_32x32x16_bf16 v[80:95], v[116:119], v[16:19], v[80:95]
    buffer_load_dwordx4 v[180:183], v2, s[24:27], s64 offen offset:1024 sc1
    v_exp_f32 v106, v106
    v_exp_f32 v107, v107
    v_exp_f32 v108, v108
    v_exp_f32 v109, v109
    v_smfmac_f32_32x32x32_bf16 v[64:79], v[120:123], v[96:103], v8
    v_exp_f32 v110, v110
    v_exp_f32 v111, v111
    s_waitcnt lgkmcnt(0)
    ds_read2st64_b64 v[112:115], v3 offset0:1 offset1:5
    ds_read_b64 v[12:13], v5 offset:512
    v_exp_f32 v80, v80
    v_exp_f32 v81, v81
    v_smfmac_f32_32x32x32_bf16 v[64:79], v[124:127], v[104:111], v8
    buffer_load_dwordx4 v[220:223], v2, s[24:27], s64 offen offset:2048 sc1
    s_add_u32 s64, s64, 6144
    v_exp_f32 v82, v82
    v_exp_f32 v83, v83
    v_exp_f32 v84, v84
    v_exp_f32 v85, v85
    v_mfma_f32_32x32x8_bf16 v[96:111], v[10:11], v[30:31], v[32:47]
    ds_read_b64_tr_b16 v[120:121], v6 offset:512
    v_exp_f32 v86, v86
    v_exp_f32 v87, v87
    ds_read_b64_tr_b16 v[122:123], v6 offset:544
    v_exp_f32 v88, v88
    v_exp_f32 v89, v89
    v_mfma_f32_32x32x16_bf16 v[96:111], v[116:119], v[20:23], v[96:111]
    buffer_load_dwordx4 v[144:147], v2, s[24:27], s64 offen offset:0 sc1
    v_exp_f32 v90, v90
    v_exp_f32 v91, v91
    v_exp_f32 v92, v92
    v_exp_f32 v93, v93
    v_smfmac_f32_32x32x32_bf16 v[48:63], v[128:131], v[80:87], v8
    v_exp_f32 v94, v94
    v_exp_f32 v95, v95
    s_waitcnt lgkmcnt(0)
    s_setprio 2
    v_exp_f32 v96, v96
    v_exp_f32 v97, v97
    v_smfmac_f32_32x32x32_bf16 v[48:63], v[132:135], v[88:95], v8
    v_exp_f32 v98, v98
    v_exp_f32 v99, v99
    v_exp_f32 v100, v100
    v_exp_f32 v101, v101
    v_mfma_f32_32x32x8_bf16 v[80:95], v[12:13], v[24:25], v[32:47]
    ds_read_b64_tr_b16 v[124:125], v6 offset:640
    v_exp_f32 v102, v102
    v_exp_f32 v103, v103
    ds_read_b64_tr_b16 v[126:127], v6 offset:672
    v_exp_f32 v104, v104
    v_exp_f32 v105, v105
    v_mfma_f32_32x32x16_bf16 v[80:95], v[112:115], v[16:19], v[80:95]
    buffer_load_dwordx4 v[184:187], v2, s[24:27], s64 offen offset:1024 sc1
    v_exp_f32 v106, v106
    v_exp_f32 v107, v107
    v_exp_f32 v108, v108
    v_exp_f32 v109, v109
    v_smfmac_f32_32x32x32_bf16 v[64:79], v[128:131], v[96:103], v8
    v_exp_f32 v110, v110
    v_exp_f32 v111, v111
    s_waitcnt lgkmcnt(0)
    s_setprio 1
    ds_read2st64_b64 v[116:119], v4 offset0:1 offset1:5
    v_exp_f32 v80, v80
    v_exp_f32 v81, v81
    v_smfmac_f32_32x32x32_bf16 v[64:79], v[132:135], v[104:111], v8
    buffer_load_dwordx4 v[224:227], v2, s[24:27], s64 offen offset:2048 sc1
    s_add_u32 s64, s64, 6144
    v_exp_f32 v82, v82
    v_exp_f32 v83, v83
    v_exp_f32 v84, v84
    v_exp_f32 v85, v85
    v_mfma_f32_32x32x8_bf16 v[96:111], v[12:13], v[28:29], v[32:47]
    ds_read_b64_tr_b16 v[128:129], v6 offset:768
    v_exp_f32 v86, v86
    v_exp_f32 v87, v87
    ds_read_b64_tr_b16 v[130:131], v6 offset:800
    v_exp_f32 v88, v88
    v_exp_f32 v89, v89
    v_mfma_f32_32x32x16_bf16 v[96:111], v[112:115], v[20:23], v[96:111]
    buffer_load_dwordx4 v[148:151], v2, s[24:27], s64 offen offset:0 sc1
    v_exp_f32 v90, v90
    v_exp_f32 v91, v91
    v_exp_f32 v92, v92
    v_exp_f32 v93, v93
    v_smfmac_f32_32x32x32_bf16 v[48:63], v[120:123], v[80:87], v8
    v_exp_f32 v94, v94
    v_exp_f32 v95, v95
    s_waitcnt lgkmcnt(0)
    s_setprio 0
    v_exp_f32 v96, v96
    v_exp_f32 v97, v97
    v_smfmac_f32_32x32x32_bf16 v[48:63], v[124:127], v[88:95], v8
    buffer_load_dwordx4 v[188:191], v2, s[24:27], s64 offen offset:1024 sc1
    v_exp_f32 v98, v98
    v_exp_f32 v99, v99
    v_exp_f32 v100, v100
    v_exp_f32 v101, v101
    v_mfma_f32_32x32x8_bf16 v[80:95], v[12:13], v[26:27], v[32:47]
    ds_read_b64_tr_b16 v[132:133], v6 offset:896
    v_exp_f32 v102, v102
    v_exp_f32 v103, v103
    ds_read_b64_tr_b16 v[134:135], v6 offset:928
    v_exp_f32 v104, v104
    v_exp_f32 v105, v105
    v_mfma_f32_32x32x16_bf16 v[80:95], v[116:119], v[16:19], v[80:95]
    buffer_load_dwordx4 v[228:231], v2, s[24:27], s64 offen offset:2048 sc1
    s_add_u32 s64, s64, 6144
    v_exp_f32 v106, v106
    v_exp_f32 v107, v107
    v_exp_f32 v108, v108
    v_exp_f32 v109, v109
    v_smfmac_f32_32x32x32_bf16 v[64:79], v[120:123], v[96:103], v8
    s_waitcnt vmcnt(12)
    v_exp_f32 v110, v110
    v_exp_f32 v111, v111
    s_waitcnt lgkmcnt(0)
    s_barrier
    v_add_u32 v3, 0x5100, v3
    v_add_u32 v4, 0x5100, v4
    v_add_u32 v5, 0x5100, v5
    v_and_b32 v0, 0x5100, v7
    v_add_u32 v6, v6, v0
    s_setprio 3
    ds_read2st64_b64 v[112:115], v3 offset0:0 offset1:4
    ds_read_b64 v[10:11], v5 offset:0
    v_exp_f32 v80, v80
    v_exp_f32 v81, v81
    v_smfmac_f32_32x32x32_bf16 v[64:79], v[124:127], v[104:111], v8
    v_exp_f32 v82, v82
    v_exp_f32 v83, v83
    v_exp_f32 v84, v84
    v_exp_f32 v85, v85
    v_mfma_f32_32x32x8_bf16 v[96:111], v[12:13], v[30:31], v[32:47]
    ds_read_b64_tr_b16 v[120:121], v6 offset:0
    v_exp_f32 v86, v86
    v_exp_f32 v87, v87
    ds_read_b64_tr_b16 v[122:123], v6 offset:32
    v_exp_f32 v88, v88
    v_exp_f32 v89, v89
    v_mfma_f32_32x32x16_bf16 v[96:111], v[116:119], v[20:23], v[96:111]
    v_exp_f32 v90, v90
    v_exp_f32 v91, v91
    v_exp_f32 v92, v92
    v_exp_f32 v93, v93
    v_smfmac_f32_32x32x32_bf16 v[48:63], v[128:131], v[80:87], v8
    s_lshl_b32 s52, s61, 11
    s_add_u32 s61, s61, 1
    s_and_b32 s61, s61, 7
    s_add_u32 m0, s58, 99328
    s_add_u32 s53, s55, s52
    buffer_load_dwordx4 v2, s[24:27], s53 offen sc1 lds
    s_add_u32 m0, s59, 99328
    s_add_u32 s53, s56, s52
    buffer_load_dwordx4 v2, s[24:27], s53 offen sc1 lds
    s_cmp_ge_u32 s46, 4
    s_cbranch_scc1 Ld_40
    s_add_u32 m0, s60, 99328
    s_add_u32 s53, s57, s52
    buffer_load_dwordx4 v2, s[24:27], s53 offen sc1 lds
Ld_40:
    v_exp_f32 v94, v94
    v_exp_f32 v95, v95
    s_waitcnt lgkmcnt(0)
    v_exp_f32 v96, v96
    v_exp_f32 v97, v97
    v_smfmac_f32_32x32x32_bf16 v[48:63], v[132:135], v[88:95], v8
    v_exp_f32 v98, v98
    v_exp_f32 v99, v99
    v_exp_f32 v100, v100
    v_exp_f32 v101, v101
    v_mfma_f32_32x32x8_bf16 v[80:95], v[10:11], v[24:25], v[32:47]
    ds_read_b64_tr_b16 v[124:125], v6 offset:128
    v_exp_f32 v102, v102
    v_exp_f32 v103, v103
    ds_read_b64_tr_b16 v[126:127], v6 offset:160
    v_exp_f32 v104, v104
    v_exp_f32 v105, v105
    v_mfma_f32_32x32x16_bf16 v[80:95], v[112:115], v[16:19], v[80:95]
    buffer_load_dwordx4 v[152:155], v2, s[24:27], s64 offen offset:0 sc1
    v_exp_f32 v106, v106
    v_exp_f32 v107, v107
    v_exp_f32 v108, v108
    v_exp_f32 v109, v109
    v_smfmac_f32_32x32x32_bf16 v[64:79], v[128:131], v[96:103], v8
    s_cmp_lg_u32 s46, 5
    s_cbranch_scc1 Lon_41
    s_mov_b32 s52, s45
L_pc_b:
    s_getpc_b64 s[82:83]
    s_mul_i32 s52, s52, 640
    v_lshlrev_b32 v252, 7, v1
    v_add_u32 v252, s52, v252
    v_min_u32 v252, 0x406c, v252
    v_mov_b32 v253, s83
    v_add_co_u32 v252, vcc, s82, v252
    s_nop 1
    v_addc_co_u32 v253, vcc, 0, v253, vcc
    s_mov_b32 exec_lo, 0x1f
    s_mov_b32 exec_hi, 0
    global_load_dword v9, v[252:253], off
    s_mov_b64 exec, -1
Lon_41:
    v_exp_f32 v110, v110
    v_exp_f32 v111, v111
    s_waitcnt lgkmcnt(0)
    ds_read2st64_b64 v[116:119], v4 offset0:0 offset1:4
    v_exp_f32 v80, v80
    v_exp_f32 v81, v81
    v_smfmac_f32_32x32x32_bf16 v[64:79], v[132:135], v[104:111], v8
    buffer_load_dwordx4 v[192:195], v2, s[24:27], s64 offen offset:1024 sc1
    v_exp_f32 v82, v82
    v_exp_f32 v83, v83
    v_exp_f32 v84, v84
    v_exp_f32 v85, v85
    v_mfma_f32_32x32x8_bf16 v[96:111], v[10:11], v[28:29], v[32:47]
    ds_read_b64_tr_b16 v[128:129], v6 offset:256
    v_exp_f32 v86, v86
    v_exp_f32 v87, v87
    ds_read_b64_tr_b16 v[130:131], v6 offset:288
    v_exp_f32 v88, v88
    v_exp_f32 v89, v89
    v_mfma_f32_32x32x16_bf16 v[96:111], v[112:115], v[20:23], v[96:111]
    buffer_load_dwordx4 v[232:235], v2, s[24:27], s64 offen offset:2048 sc1
    s_add_u32 s64, s64, 6144
    v_exp_f32 v90, v90
    v_exp_f32 v91, v91
    v_exp_f32 v92, v92
    v_exp_f32 v93, v93
    v_smfmac_f32_32x32x32_bf16 v[48:63], v[120:123], v[80:87], v8
    v_exp_f32 v94, v94
    v_exp_f32 v95, v95
    s_waitcnt lgkmcnt(0)
    v_exp_f32 v96, v96
    v_exp_f32 v97, v97
    v_smfmac_f32_32x32x32_bf16 v[48:63], v[124:127], v[88:95], v8
    buffer_load_dwordx4 v[156:159], v2, s[24:27], s64 offen offset:0 sc1
    v_exp_f32 v98, v98
    v_exp_f32 v99, v99
    v_exp_f32 v100, v100
    v_exp_f32 v101, v101
    v_mfma_f32_32x32x8_bf16 v[80:95], v[10:11], v[26:27], v[32:47]
    ds_read_b64_tr_b16 v[132:133], v6 offset:384
    v_exp_f32 v102, v102
    v_exp_f32 v103, v103
    ds_read_b64_tr_b16 v[134:135], v6 offset:416
    v_exp_f32 v104, v104
    v_exp_f32 v105, v105
    v_mfma_f32_32x32x16_bf16 v[80:95], v[116:119], v[16:19], v[80:95]
    buffer_load_dwordx4 v[196:199], v2, s[24:27], s64 offen offset:1024 sc1
    v_exp_f32 v106, v106
    v_exp_f32 v107, v107
    v_exp_f32 v108, v108
    v_exp_f32 v109, v109
    v_smfmac_f32_32x32x32_bf16 v[64:79], v[120:123], v[96:103], v8
    v_exp_f32 v110, v110
    v_exp_f32 v111, v111
    s_waitcnt lgkmcnt(0)
    ds_read2st64_b64 v[112:115], v3 offset0:1 offset1:5
    ds_read_b64 v[12:13], v5 offset:512
    v_exp_f32 v80, v80
    v_exp_f32 v81, v81
    v_smfmac_f32_32x32x32_bf16 v[64:79], v[124:127], v[104:111], v8
    v_exp_f32 v82, v82
    v_exp_f32 v83, v83
    v_exp_f32 v84, v84
    v_exp_f32 v85, v85
    v_mfma_f32_32x32x8_bf16 v[96:111], v[10:11], v[30:31], v[32:47]
    ds_read_b64_tr_b16 v[120:121], v6 offset:512
    v_exp_f32 v86, v86
    v_exp_f32 v87, v87
    ds_read_b64_tr_b16 v[122:123], v6 offset:544
    v_exp_f32 v88, v88
    v_exp_f32 v89, v89
    v_mfma_f32_32x32x16_bf16 v[96:111], v[116:119], v[20:23], v[96:111]
    buffer_load_dwordx4 v[236:239], v2, s[24:27], s64 offen offset:2048 sc1
    s_add_u32 s64, s64, 6144
    v_exp_f32 v90, v90
    v_exp_f32 v91, v91
    v_exp_f32 v92, v92
    v_exp_f32 v93, v93
    v_smfmac_f32_32x32x32_bf16 v[48:63], v[128:131], v[80:87], v8
    v_exp_f32 v94, v94
    v_exp_f32 v95, v95
    s_waitcnt lgkmcnt(0)
    s_setprio 2
    v_exp_f32 v96, v96
    v_exp_f32 v97, v97
    v_smfmac_f32_32x32x32_bf16 v[48:63], v[132:135], v[88:95], v8
    buffer_load_dwordx4 v[160:163], v2, s[24:27], s64 offen offset:0 sc1
    v_exp_f32 v98, v98
    v_exp_f32 v99, v99
    v_exp_f32 v100, v100
    v_exp_f32 v101, v101
    v_mfma_f32_32x32x8_bf16 v[80:95], v[12:13], v[24:25], v[32:47]
    ds_read_b64_tr_b16 v[124:125], v6 offset:640
    v_exp_f32 v102, v102
    v_exp_f32 v103, v103
    ds_read_b64_tr_b16 v[126:127], v6 offset:672
    v_exp_f32 v104, v104
    v_exp_f32 v105, v105
    v_mfma_f32_32x32x16_bf16 v[80:95], v[112:115], v[16:19], v[80:95]
    buffer_load_dwordx4 v[200:203], v2, s[24:27], s64 offen offset:1024 sc1
    v_exp_f32 v106, v106
    v_exp_f32 v107, v107
    v_exp_f32 v108, v108
    v_exp_f32 v109, v109
    v_smfmac_f32_32x32x32_bf16 v[64:79], v[128:131], v[96:103], v8
    v_exp_f32 v110, v110
    v_exp_f32 v111, v111
    s_waitcnt lgkmcnt(0)
    s_setprio 1
    ds_read2st64_b64 v[116:119], v4 offset0:1 offset1:5
    v_exp_f32 v80, v80
    v_exp_f32 v81, v81
    v_smfmac_f32_32x32x32_bf16 v[64:79], v[132:135], v[104:111], v8
    buffer_load_dwordx4 v[240:243], v2, s[24:27], s64 offen offset:2048 sc1
    s_add_u32 s64, s64, 6144
    v_exp_f32 v82, v82
    v_exp_f32 v83, v83
    v_exp_f32 v84, v84
    v_exp_f32 v85, v85
    v_mfma_f32_32x32x8_bf16 v[96:111], v[12:13], v[28:29], v[32:47]
    ds_read_b64_tr_b16 v[128:129], v6 offset:768
    v_exp_f32 v86, v86
    v_exp_f32 v87, v87
    ds_read_b64_tr_b16 v[130:131], v6 offset:800
    v_exp_f32 v88, v88
    v_exp_f32 v89, v89
    v_mfma_f32_32x32x16_bf16 v[96:111], v[112:115], v[20:23], v[96:111]
    buffer_load_dwordx4 v[164:167], v2, s[24:27], s64 offen offset:0 sc1
    v_exp_f32 v90, v90
    v_exp_f32 v91, v91
    v_exp_f32 v92, v92
    v_exp_f32 v93, v93
    v_smfmac_f32_32x32x32_bf16 v[48:63], v[120:123], v[80:87], v8
    v_exp_f32 v94, v94
    v_exp_f32 v95, v95
    s_waitcnt lgkmcnt(0)
    s_setprio 0
    v_exp_f32 v96, v96
    v_exp_f32 v97, v97
    v_smfmac_f32_32x32x32_bf16 v[48:63], v[124:127], v[88:95], v8
    v_exp_f32 v98, v98
    v_exp_f32 v99, v99
    v_exp_f32 v100, v100
    v_exp_f32 v101, v101
    v_mfma_f32_32x32x8_bf16 v[80:95], v[12:13], v[26:27], v[32:47]
    ds_read_b64_tr_b16 v[132:133], v6 offset:896
    v_exp_f32 v102, v102
    v_exp_f32 v103, v103
    ds_read_b64_tr_b16 v[134:135], v6 offset:928
    v_exp_f32 v104, v104
    v_exp_f32 v105, v105
    v_mfma_f32_32x32x16_bf16 v[80:95], v[116:119], v[16:19], v[80:95]
    buffer_load_dwordx4 v[204:207], v2, s[24:27], s64 offen offset:1024 sc1
    v_exp_f32 v106, v106
    v_exp_f32 v107, v107
    v_exp_f32 v108, v108
    v_exp_f32 v109, v109
    v_smfmac_f32_32x32x32_bf16 v[64:79], v[120:123], v[96:103], v8
    s_waitcnt vmcnt(11)
    v_exp_f32 v110, v110
    v_exp_f32 v111, v111
    s_waitcnt lgkmcnt(0)
    s_barrier
    v_add_u32 v3, 0xffff5e00, v3
    v_add_u32 v4, 0xffff5e00, v4
    v_add_u32 v5, 0xffff5e00, v5
    v_and_b32 v0, 0xffff5e00, v7
    v_add_u32 v6, v6, v0
    s_setprio 3
    ds_read2st64_b64 v[112:115], v3 offset0:0 offset1:4
    ds_read_b64 v[10:11], v5 offset:0
    v_exp_f32 v80, v80
    v_exp_f32 v81, v81
    v_smfmac_f32_32x32x32_bf16 v[64:79], v[124:127], v[104:111], v8
    v_exp_f32 v82, v82
    v_exp_f32 v83, v83
    v_exp_f32 v84, v84
    v_exp_f32 v85, v85
    v_mfma_f32_32x32x8_bf16 v[96:111], v[12:13], v[30:31], v[32:47]
    ds_read_b64_tr_b16 v[120:121], v6 offset:0
    v_exp_f32 v86, v86
    v_exp_f32 v87, v87
    ds_read_b64_tr_b16 v[122:123], v6 offset:32
    v_exp_f32 v88, v88
    v_exp_f32 v89, v89
    v_mfma_f32_32x32x16_bf16 v[96:111], v[116:119], v[20:23], v[96:111]
    buffer_load_dwordx4 v[244:247], v2, s[24:27], s64 offen offset:2048 sc1
    s_add_u32 s64, s64, 6144
    v_exp_f32 v90, v90
    v_exp_f32 v91, v91
    v_exp_f32 v92, v92
    v_exp_f32 v93, v93
    v_smfmac_f32_32x32x32_bf16 v[48:63], v[128:131], v[80:87], v8
    v_exp_f32 v94, v94
    v_exp_f32 v95, v95
    s_waitcnt lgkmcnt(0)
    v_exp_f32 v96, v96
    v_exp_f32 v97, v97
    v_smfmac_f32_32x32x32_bf16 v[48:63], v[132:135], v[88:95], v8
    v_exp_f32 v98, v98
    v_exp_f32 v99, v99
    v_exp_f32 v100, v100
    v_exp_f32 v101, v101
    v_mfma_f32_32x32x8_bf16 v[80:95], v[10:11], v[24:25], v[32:47]
    ds_read_b64_tr_b16 v[124:125], v6 offset:128
    v_exp_f32 v102, v102
    v_exp_f32 v103, v103
    ds_read_b64_tr_b16 v[126:127], v6 offset:160
    v_exp_f32 v104, v104
    v_exp_f32 v105, v105
    v_mfma_f32_32x32x16_bf16 v[80:95], v[112:115], v[16:19], v[80:95]
    buffer_load_dwordx4 v[168:171], v2, s[24:27], s64 offen offset:0 sc1
    v_exp_f32 v106, v106
    v_exp_f32 v107, v107
    v_exp_f32 v108, v108
    v_exp_f32 v109, v109
    v_smfmac_f32_32x32x32_bf16 v[64:79], v[128:131], v[96:103], v8
    s_cmp_lg_u32 s46, 6
    s_cbranch_scc1 Lon_42
    v_lshlrev_b32 v14, 7, v1
    s_mov_b64 exec, 0xff
    s_lshl_b32 s52, s44, 10
    s_add_u32 s52, s52, 21069824
    buffer_load_dword v9, v14, s[24:27], s52 offen sc1
    s_mov_b64 exec, 0x3
    s_lshl_b32 s52, s96, 8
    s_add_u32 s53, s52, 21102592
    buffer_load_dword v9, v14, s[24:27], s53 offen sc1
    s_add_u32 s53, s52, 21135360
    buffer_load_dword v9, v14, s[24:27], s53 offen sc1
    s_mov_b64 exec, -1
Lon_42:
    v_exp_f32 v110, v110
    v_exp_f32 v111, v111
    s_waitcnt lgkmcnt(0)
    ds_read2st64_b64 v[116:119], v4 offset0:0 offset1:4
    v_exp_f32 v80, v80
    v_exp_f32 v81, v81
    v_smfmac_f32_32x32x32_bf16 v[64:79], v[132:135], v[104:111], v8
    v_exp_f32 v82, v82
    v_exp_f32 v83, v83
    v_exp_f32 v84, v84
    v_exp_f32 v85, v85
    v_mfma_f32_32x32x8_bf16 v[96:111], v[10:11], v[28:29], v[32:47]
    ds_read_b64_tr_b16 v[128:129], v6 offset:256
    v_exp_f32 v86, v86
    v_exp_f32 v87, v87
    ds_read_b64_tr_b16 v[130:131], v6 offset:288
    v_exp_f32 v88, v88
    v_exp_f32 v89, v89
    v_mfma_f32_32x32x16_bf16 v[96:111], v[112:115], v[20:23], v[96:111]
    buffer_load_dwordx4 v[208:211], v2, s[24:27], s64 offen offset:1024 sc1
    v_exp_f32 v90, v90
    v_exp_f32 v91, v91
    v_exp_f32 v92, v92
    v_exp_f32 v93, v93
    v_smfmac_f32_32x32x32_bf16 v[48:63], v[120:123], v[80:87], v8
    v_exp_f32 v94, v94
    v_exp_f32 v95, v95
    s_waitcnt lgkmcnt(0)
    v_exp_f32 v96, v96
    v_exp_f32 v97, v97
    v_smfmac_f32_32x32x32_bf16 v[48:63], v[124:127], v[88:95], v8
    v_exp_f32 v98, v98
    v_exp_f32 v99, v99
    v_exp_f32 v100, v100
    v_exp_f32 v101, v101
    v_mfma_f32_32x32x8_bf16 v[80:95], v[10:11], v[26:27], v[32:47]
    ds_read_b64_tr_b16 v[132:133], v6 offset:384
    v_exp_f32 v102, v102
    v_exp_f32 v103, v103
    ds_read_b64_tr_b16 v[134:135], v6 offset:416
    v_exp_f32 v104, v104
    v_exp_f32 v105, v105
    v_mfma_f32_32x32x16_bf16 v[80:95], v[116:119], v[16:19], v[80:95]
    buffer_load_dwordx4 v[248:251], v2, s[24:27], s64 offen offset:2048 sc1
    s_add_u32 s64, s64, 6144
    v_exp_f32 v106, v106
    v_exp_f32 v107, v107
    v_exp_f32 v108, v108
    v_exp_f32 v109, v109
    v_smfmac_f32_32x32x32_bf16 v[64:79], v[120:123], v[96:103], v8
    v_exp_f32 v110, v110
    v_exp_f32 v111, v111
    s_waitcnt lgkmcnt(0)
    ds_read2st64_b64 v[112:115], v3 offset0:1 offset1:5
    ds_read_b64 v[12:13], v5 offset:512
    v_exp_f32 v80, v80
    v_exp_f32 v81, v81
    v_smfmac_f32_32x32x32_bf16 v[64:79], v[124:127], v[104:111], v8
    v_exp_f32 v82, v82
    v_exp_f32 v83, v83
    v_exp_f32 v84, v84
    v_exp_f32 v85, v85
    v_mfma_f32_32x32x8_bf16 v[96:111], v[10:11], v[30:31], v[32:47]
    ds_read_b64_tr_b16 v[120:121], v6 offset:512
    v_exp_f32 v86, v86
    v_exp_f32 v87, v87
    ds_read_b64_tr_b16 v[122:123], v6 offset:544
    v_exp_f32 v88, v88
    v_exp_f32 v89, v89
    v_mfma_f32_32x32x16_bf16 v[96:111], v[116:119], v[20:23], v[96:111]
    buffer_load_dwordx4 v[172:175], v2, s[24:27], s64 offen offset:0 sc1
    v_exp_f32 v90, v90
    v_exp_f32 v91, v91
    v_exp_f32 v92, v92
    v_exp_f32 v93, v93
    v_smfmac_f32_32x32x32_bf16 v[48:63], v[128:131], v[80:87], v8
    v_exp_f32 v94, v94
    v_exp_f32 v95, v95
    s_waitcnt lgkmcnt(0)
    s_setprio 2
    v_exp_f32 v96, v96
    v_exp_f32 v97, v97
    v_smfmac_f32_32x32x32_bf16 v[48:63], v[132:135], v[88:95], v8
    v_exp_f32 v98, v98
    v_exp_f32 v99, v99
    v_exp_f32 v100, v100
    v_exp_f32 v101, v101
    v_mfma_f32_32x32x8_bf16 v[80:95], v[12:13], v[24:25], v[32:47]
    ds_read_b64_tr_b16 v[124:125], v6 offset:640
    v_exp_f32 v102, v102
    v_exp_f32 v103, v103
    ds_read_b64_tr_b16 v[126:127], v6 offset:672
    v_exp_f32 v104, v104
    v_exp_f32 v105, v105
    v_mfma_f32_32x32x16_bf16 v[80:95], v[112:115], v[16:19], v[80:95]
    buffer_load_dwordx4 v[212:215], v2, s[24:27], s64 offen offset:1024 sc1
    v_exp_f32 v106, v106
    v_exp_f32 v107, v107
    v_exp_f32 v108, v108
    v_exp_f32 v109, v109
    v_smfmac_f32_32x32x32_bf16 v[64:79], v[128:131], v[96:103], v8
    v_exp_f32 v110, v110
    v_exp_f32 v111, v111
    s_waitcnt lgkmcnt(0)
    s_setprio 1
    ds_read2st64_b64 v[116:119], v4 offset0:1 offset1:5
    v_exp_f32 v80, v80
    v_exp_f32 v81, v81
    v_smfmac_f32_32x32x32_bf16 v[64:79], v[132:135], v[104:111], v8
    v_exp_f32 v82, v82
    v_exp_f32 v83, v83
    v_exp_f32 v84, v84
    v_exp_f32 v85, v85
    v_mfma_f32_32x32x8_bf16 v[96:111], v[12:13], v[28:29], v[32:47]
    ds_read_b64_tr_b16 v[128:129], v6 offset:768
    v_exp_f32 v86, v86
    v_exp_f32 v87, v87
    ds_read_b64_tr_b16 v[130:131], v6 offset:800
    v_exp_f32 v88, v88
    v_exp_f32 v89, v89
    v_mfma_f32_32x32x16_bf16 v[96:111], v[112:115], v[20:23], v[96:111]
    buffer_load_dwordx4 v[252:255], v2, s[24:27], s64 offen offset:2048 sc1
    s_add_u32 s64, s64, 6144
    v_exp_f32 v90, v90
    v_exp_f32 v91, v91
    v_exp_f32 v92, v92
    v_exp_f32 v93, v93
    v_smfmac_f32_32x32x32_bf16 v[48:63], v[120:123], v[80:87], v8
    v_exp_f32 v94, v94
    v_exp_f32 v95, v95
    s_waitcnt lgkmcnt(0)
    s_setprio 0
    v_exp_f32 v96, v96
    v_exp_f32 v97, v97
    v_smfmac_f32_32x32x32_bf16 v[48:63], v[124:127], v[88:95], v8
    v_exp_f32 v98, v98
    v_exp_f32 v99, v99
    v_exp_f32 v100, v100
    v_exp_f32 v101, v101
    v_mfma_f32_32x32x8_bf16 v[80:95], v[12:13], v[26:27], v[32:47]
    ds_read_b64_tr_b16 v[132:133], v6 offset:896
    v_exp_f32 v102, v102
    v_exp_f32 v103, v103
    ds_read_b64_tr_b16 v[134:135], v6 offset:928
    v_exp_f32 v104, v104
    v_exp_f32 v105, v105
    v_mfma_f32_32x32x16_bf16 v[80:95], v[116:119], v[16:19], v[80:95]
    v_exp_f32 v106, v106
    v_exp_f32 v107, v107
    v_exp_f32 v108, v108
    v_exp_f32 v109, v109
    v_smfmac_f32_32x32x32_bf16 v[64:79], v[120:123], v[96:103], v8
    s_lshl_b32 s52, s46, 12
    s_add_u32 s52, s52, 120064
    v_add_u32 v3, s52, v2
    s_xor_b32 s53, s46, 4
    s_lshl_b32 s53, s53, 12
    s_add_u32 s53, s53, 120064
    v_add_u32 v4, s53, v2
    v_and_b32 v112, 15, v1
    v_bfe_u32 v113, v1, 4, 1
    v_lshrrev_b32 v114, 5, v1
    v_mul_u32_u24 v113, 20480, v113
    v_lshl_add_u32 v115, v112, 4, v113
    v_lshl_add_u32 v115, v114, 8, v115
    v_lshl_add_u32 v113, v112, 3, v113
    s_mul_i32 s75, s67, 40960
    s_add_u32 s75, s75, 8388608
    s_lshl_b32 s54, s92, 9
    s_add_u32 s77, s75, s54
    s_lshl_b32 s54, s92, 7
    s_add_u32 s75, s75, s54
    s_add_u32 s75, s75, 16384
    v_exp_f32 v110, v110
    v_exp_f32 v111, v111
    s_waitcnt lgkmcnt(0)
    s_barrier
    s_setprio 3
    v_exp_f32 v80, v80
    v_exp_f32 v81, v81
    v_smfmac_f32_32x32x32_bf16 v[64:79], v[124:127], v[104:111], v8
    v_exp_f32 v82, v82
    v_exp_f32 v83, v83
    v_exp_f32 v84, v84
    v_exp_f32 v85, v85
    v_mfma_f32_32x32x8_bf16 v[96:111], v[12:13], v[30:31], v[32:47]
    v_exp_f32 v86, v86
    v_exp_f32 v87, v87
    v_exp_f32 v88, v88
    v_exp_f32 v89, v89
    v_mfma_f32_32x32x16_bf16 v[96:111], v[116:119], v[20:23], v[96:111]
    v_exp_f32 v90, v90
    v_exp_f32 v91, v91
    v_exp_f32 v92, v92
    v_exp_f32 v93, v93
    v_smfmac_f32_32x32x32_bf16 v[48:63], v[128:131], v[80:87], v8
    s_cmp_ge_u32 s46, 4
    s_cbranch_scc1 Lrx_43
    v_and_b32 v0, 15, v1
    v_mul_u32_u24 v0, 1280, v0
    v_lshrrev_b32 v120, 4, v1
    v_lshl_add_u32 v0, v120, 3, v0
    s_add_u32 s52, s46, s95
    s_mul_i32 s52, s52, 20480
    s_add_u32 s52, s52, s97
    buffer_load_dwordx2 v[120:121], v0, s[4:7], s52 offen offset:0
    buffer_load_dwordx2 v[122:123], v0, s[4:7], s52 offen offset:32
    buffer_load_dwordx2 v[124:125], v0, s[4:7], s52 offen offset:64
    buffer_load_dwordx2 v[126:127], v0, s[4:7], s52 offen offset:96
    buffer_load_dwordx2 v[10:11], v0, s[4:7], s52 offen offset:128
Lrx_43:
    v_exp_f32 v94, v94
    v_exp_f32 v95, v95
    s_waitcnt lgkmcnt(0)
    v_exp_f32 v96, v96
    v_exp_f32 v97, v97
    v_smfmac_f32_32x32x32_bf16 v[48:63], v[132:135], v[88:95], v8
    v_exp_f32 v98, v98
    v_exp_f32 v99, v99
    v_exp_f32 v100, v100
    v_exp_f32 v101, v101
    v_exp_f32 v102, v102
    v_exp_f32 v103, v103
    v_exp_f32 v104, v104
    v_exp_f32 v105, v105
    v_mov_b32 v61, v32
    ds_write_b128 v3, v[48:51] offset:0
    ds_write_b128 v3, v[52:55] offset:1024
    ds_write_b128 v3, v[56:59] offset:2048
    ds_write_b128 v3, v[60:63] offset:3072
    v_exp_f32 v106, v106
    v_exp_f32 v107, v107
    v_exp_f32 v108, v108
    v_exp_f32 v109, v109
    v_smfmac_f32_32x32x32_bf16 v[64:79], v[128:131], v[96:103], v8
    s_waitcnt lgkmcnt(0)
    s_barrier
    ds_read_b128 v[92:95], v4 offset:3072
    ds_read_b128 v[80:83], v4 offset:0
    ds_read_b128 v[84:87], v4 offset:1024
    ds_read_b128 v[88:91], v4 offset:2048
    v_exp_f32 v110, v110
    v_exp_f32 v111, v111
    s_nop 1
    v_smfmac_f32_32x32x32_bf16 v[64:79], v[132:135], v[104:111], v8
    s_setprio 0
    s_waitcnt lgkmcnt(3)
    v_min_f32 v112, v32, v93
    v_sub_f32 v116, v112, v32
    v_sub_f32 v117, v112, v93
    v_exp_f32 v116, v116
    v_exp_f32 v117, v117
    s_cmp_ge_u32 s46, 4
    s_cbranch_scc1 Lwt_44
    s_lshl_b32 s52, s46, 10
    s_add_u32 s53, s52, s69
    s_add_u32 s53, s53, 344064
    s_add_u32 m0, s52, 98304
    s_nop 0
    buffer_load_dwordx4 v2, s[24:27], s53 offen sc1 lds
Lwt_44:
    v_mul_f32 v112, v117, v92
    s_mov_b32 s78, 0
    s_waitcnt lgkmcnt(0)
    v_mul_f32 v80, v80, v117
    v_mul_f32 v81, v81, v117
    v_mul_f32 v82, v82, v117
    v_mul_f32 v83, v83, v117
    v_mul_f32 v84, v84, v117
    v_mul_f32 v85, v85, v117
    v_mul_f32 v86, v86, v117
    v_mul_f32 v87, v87, v117
    v_mul_f32 v88, v88, v117
    v_mul_f32 v89, v89, v117
    v_mul_f32 v90, v90, v117
    v_mul_f32 v91, v91, v117
    v_fmac_f32 v112, v116, v76
    v_rcp_f32 v114, v112
    v_fmac_f32 v80, v64, v116
    v_fmac_f32 v81, v65, v116
    v_fmac_f32 v82, v66, v116
    v_fmac_f32 v83, v67, v116
    v_fmac_f32 v84, v68, v116
    v_fmac_f32 v85, v69, v116
    v_fmac_f32 v86, v70, v116
    v_fmac_f32 v87, v71, v116
    v_fmac_f32 v88, v72, v116
    v_fmac_f32 v89, v73, v116
    v_fmac_f32 v90, v74, v116
    v_fmac_f32 v91, v75, v116
    v_mul_f32 v64, v80, v114
    v_mul_f32 v65, v81, v114
    v_mul_f32 v66, v82, v114
    v_mul_f32 v67, v83, v114
    v_mul_f32 v68, v84, v114
    v_mul_f32 v69, v85, v114
    v_mul_f32 v70, v86, v114
    v_mul_f32 v71, v87, v114
    v_mul_f32 v72, v88, v114
    v_mul_f32 v73, v89, v114
    v_mul_f32 v74, v90, v114
    v_mul_f32 v75, v91, v114
L_B_back:
    v_cvt_pk_bf16_f32 v96, v64, v65
    v_cvt_pk_bf16_f32 v97, v66, v67
    v_cvt_pk_bf16_f32 v98, v68, v69
    v_cvt_pk_bf16_f32 v99, v70, v71
    v_cvt_pk_bf16_f32 v100, v72, v73
    v_cvt_pk_bf16_f32 v101, v74, v75
    buffer_store_dwordx4 v[96:99], v115, s[24:27], s77 offen sc1
    s_mov_b32 exec_hi, 0
    buffer_store_dwordx2 v[100:101], v113, s[24:27], s75 offen sc1
    s_mov_b64 exec, -1
    s_cmp_eq_u32 s78, 1
    s_cbranch_scc1 L_B_ok
    v_max_f32 v114, v76, v92
    v_mul_f32 v116, 0, v64
    v_mul_f32 v117, 0, v65
    v_fmac_f32 v116, 0, v66
    v_fmac_f32 v117, 0, v67
    v_fmac_f32 v116, 0, v68
    v_fmac_f32 v117, 0, v69
    v_fmac_f32 v116, 0, v70
    v_fmac_f32 v117, 0, v71
    v_fmac_f32 v116, 0, v72
    v_fmac_f32 v117, 0, v73
    v_fmac_f32 v116, 0, v74
    v_fmac_f32 v117, 0, v75
    v_add3_u32 v116, v116, v116, 0
    v_add3_u32 v117, v117, v117, 0
    v_or_b32 v116, v116, v117
    v_cmp_nge_f32 vcc, 0x53800000, v114
    v_cmp_ne_u32 s[80:81], 0, v116
    s_nop 0
    s_or_b64 s[80:81], s[80:81], vcc
    v_cmp_nle_f32 vcc, 0x2b800000, v112
    s_nop 0
    s_or_b64 vcc, vcc, s[80:81]
    s_cbranch_vccnz L_B_slow
L_B_ok:
    s_lshl_b32 s52, s93, 10
    s_lshl_b32 s53, s92, 5
    s_add_u32 s52, s52, s53
    s_add_u32 s52, s52, 21069824
    v_mov_b32 v4, s48
    v_mov_b32 v5, s49
    v_lshlrev_b32 v6, 3, v1
    s_cmp_lg_u32 s46, 7
    s_waitcnt vmcnt(0)
    s_barrier
    s_cbranch_scc1 Lff_45
    s_mov_b64 exec, 0xf
    buffer_store_dwordx2 v[4:5], v6, s[24:27], s52 offen sc1
    s_mov_b64 exec, -1
Lff_45:
    v_lshrrev_b32 v41, 4, v1
    v_lshlrev_b32 v42, 3, v41
    s_mul_i32 s54, s51, 384
    s_and_b32 s53, s46, 3
    s_mul_i32 s53, s53, 96
    s_add_u32 s54, s54, s53
    buffer_load_dwordx2 v[128:129], v42, s[36:39], s54 offen offset:0
    buffer_load_dwordx2 v[130:131], v42, s[36:39], s54 offen offset:32
    buffer_load_dwordx2 v[132:133], v42, s[36:39], s54 offen offset:64
    s_cmp_ge_u32 s46, 4
    s_cbranch_scc1 L_C_help
    s_add_u32 s56, s46, s95
    v_and_b32 v40, 15, v1
    v_lshlrev_b32 v6, 8, v41
    v_lshl_add_u32 v6, v40, 3, v6
    v_add_u32 v3, 51200, v2
    v_lshlrev_b32 v16, 16, v120
    v_and_b32 v17, 0xffff0000, v120
    v_lshlrev_b32 v18, 16, v121
    v_and_b32 v19, 0xffff0000, v121
    v_lshlrev_b32 v20, 16, v122
    v_and_b32 v21, 0xffff0000, v122
    v_lshlrev_b32 v22, 16, v123
    v_and_b32 v23, 0xffff0000, v123
    v_lshlrev_b32 v24, 16, v124
    v_and_b32 v25, 0xffff0000, v124
    v_lshlrev_b32 v26, 16, v125
    v_and_b32 v27, 0xffff0000, v125
    v_lshlrev_b32 v28, 16, v126
    v_and_b32 v29, 0xffff0000, v126
    v_lshlrev_b32 v30, 16, v127
    v_and_b32 v31, 0xffff0000, v127
    v_lshlrev_b32 v32, 16, v10
    v_and_b32 v33, 0xffff0000, v10
    v_lshlrev_b32 v34, 16, v11
    v_and_b32 v35, 0xffff0000, v11
    ds_read_b128 v[36:39], v2 offset:0
    ds_read_b128 v[40:43], v2 offset:1024
    ds_read_b128 v[44:47], v2 offset:2048
    ds_read_b128 v[48:51], v2 offset:3072
    ds_read_b128 v[52:55], v2 offset:4096
    s_mul_i32 s58, s56, 20480
    s_add_u32 s52, s58, 11534336
    s_add_u32 s58, s58, 8388608
    s_lshl_b32 s53, s51, 9
    s_lshl_b32 s54, s96, 12
    s_add_u32 s54, s54, s53
    s_add_u32 s53, s53, s52
    s_add_u32 s53, s53, 16384
    s_lshl_b32 s57, s51, 11
    s_add_u32 s52, s52, s57
    s_lshl_b32 s57, s46, 7
    s_add_u32 s54, s54, s57
    s_add_u32 s54, s54, 14417920
    v_lshlrev_b32 v4, 3, v1
    v_lshlrev_b32 v5, 2, v1
    s_add_u32 s59, s58, 4096
    s_add_u32 s60, s58, 8192
    s_add_u32 s61, s58, 12288
    s_add_u32 s62, s58, 16384
    s_barrier
    buffer_load_dwordx4 v[76:79], v2, s[24:27], s58 offen offset:0 sc1
    buffer_load_dwordx4 v[80:83], v2, s[24:27], s58 offen offset:1024 sc1
    buffer_load_dwordx4 v[84:87], v2, s[24:27], s58 offen offset:2048 sc1
    buffer_load_dwordx4 v[88:91], v2, s[24:27], s58 offen offset:3072 sc1
    buffer_load_dwordx4 v[92:95], v2, s[24:27], s59 offen offset:0 sc1
    buffer_load_dwordx4 v[96:99], v2, s[24:27], s59 offen offset:1024 sc1
    buffer_load_dwordx4 v[100:103], v2, s[24:27], s59 offen offset:2048 sc1
    buffer_load_dwordx4 v[104:107], v2, s[24:27], s59 offen offset:3072 sc1
    ds_read_b128 v[56:59], v2 offset:5120
    s_waitcnt vmcnt(7) lgkmcnt(3)
    v_mfma_f32_16x16x32_bf16 v[16:19], v[36:39], v[76:79], v[16:19]
    ds_read_b128 v[60:63], v2 offset:6144
    v_mfma_f32_16x16x32_bf16 v[20:23], v[40:43], v[76:79], v[20:23]
    buffer_load_dwordx2 v[108:109], v6, s[24:27], s62 offen offset:0 sc1
    buffer_load_dwordx2 v[110:111], v6, s[24:27], s62 offen offset:128 sc1
    ds_read_b128 v[64:67], v2 offset:7168
    v_mfma_f32_16x16x32_bf16 v[24:27], v[44:47], v[76:79], v[24:27]
    ds_read_b128 v[68:71], v2 offset:8192
    s_waitcnt lgkmcnt(4)
    v_mfma_f32_16x16x32_bf16 v[28:31], v[48:51], v[76:79], v[28:31]
    buffer_load_dwordx2 v[112:113], v6, s[24:27], s62 offen offset:1024 sc1
    buffer_load_dwordx2 v[114:115], v6, s[24:27], s62 offen offset:1152 sc1
    ds_read_b128 v[72:75], v2 offset:9216
    v_mfma_f32_16x16x32_bf16 v[32:35], v[52:55], v[76:79], v[32:35]
    ds_read_b128 v[36:39], v2 offset:10240
    s_waitcnt vmcnt(10) lgkmcnt(3)
    v_mfma_f32_16x16x32_bf16 v[16:19], v[56:59], v[80:83], v[16:19]
    ds_read_b128 v[40:43], v2 offset:11264
    v_mfma_f32_16x16x32_bf16 v[20:23], v[60:63], v[80:83], v[20:23]
    buffer_load_dwordx4 v[116:119], v2, s[24:27], s60 offen offset:0 sc1
    ds_read_b128 v[44:47], v2 offset:12288
    v_mfma_f32_16x16x32_bf16 v[24:27], v[64:67], v[80:83], v[24:27]
    ds_read_b128 v[48:51], v2 offset:13312
    s_waitcnt lgkmcnt(4)
    v_mfma_f32_16x16x32_bf16 v[28:31], v[68:71], v[80:83], v[28:31]
    buffer_load_dwordx4 v[120:123], v2, s[24:27], s60 offen offset:1024 sc1
    ds_read_b128 v[52:55], v2 offset:14336
    v_mfma_f32_16x16x32_bf16 v[32:35], v[72:75], v[80:83], v[32:35]
    ds_read_b128 v[56:59], v2 offset:15360
    s_waitcnt vmcnt(11) lgkmcnt(3)
    v_mfma_f32_16x16x32_bf16 v[16:19], v[36:39], v[84:87], v[16:19]
    ds_read_b128 v[60:63], v2 offset:16384
    v_mfma_f32_16x16x32_bf16 v[20:23], v[40:43], v[84:87], v[20:23]
    buffer_load_dwordx4 v[124:127], v2, s[24:27], s60 offen offset:2048 sc1
    ds_read_b128 v[64:67], v2 offset:17408
    v_mfma_f32_16x16x32_bf16 v[24:27], v[44:47], v[84:87], v[24:27]
    ds_read_b128 v[68:71], v2 offset:18432
    s_waitcnt lgkmcnt(4)
    v_mfma_f32_16x16x32_bf16 v[28:31], v[48:51], v[84:87], v[28:31]
    buffer_load_dwordx4 v[76:79], v2, s[24:27], s60 offen offset:3072 sc1
    ds_read_b128 v[72:75], v2 offset:19456
    v_mfma_f32_16x16x32_bf16 v[32:35], v[52:55], v[84:87], v[32:35]
    ds_read_b128 v[36:39], v2 offset:20480
    s_waitcnt vmcnt(12) lgkmcnt(3)
    v_mfma_f32_16x16x32_bf16 v[16:19], v[56:59], v[88:91], v[16:19]
    ds_read_b128 v[40:43], v2 offset:21504
    v_mfma_f32_16x16x32_bf16 v[20:23], v[60:63], v[88:91], v[20:23]
    buffer_load_dwordx4 v[80:83], v2, s[24:27], s61 offen offset:0 sc1
    ds_read_b128 v[44:47], v2 offset:22528
    v_mfma_f32_16x16x32_bf16 v[24:27], v[64:67], v[88:91], v[24:27]
    ds_read_b128 v[48:51], v2 offset:23552
    s_waitcnt lgkmcnt(4)
    v_mfma_f32_16x16x32_bf16 v[28:31], v[68:71], v[88:91], v[28:31]
    buffer_load_dwordx4 v[84:87], v2, s[24:27], s61 offen offset:1024 sc1
    ds_read_b128 v[52:55], v2 offset:24576
    v_mfma_f32_16x16x32_bf16 v[32:35], v[72:75], v[88:91], v[32:35]
    ds_read_b128 v[56:59], v2 offset:25600
    s_waitcnt vmcnt(13) lgkmcnt(3)
    v_mfma_f32_16x16x32_bf16 v[16:19], v[36:39], v[92:95], v[16:19]
    ds_read_b128 v[60:63], v2 offset:26624
    v_mfma_f32_16x16x32_bf16 v[20:23], v[40:43], v[92:95], v[20:23]
    buffer_load_dwordx4 v[88:91], v2, s[24:27], s61 offen offset:2048 sc1
    ds_read_b128 v[64:67], v2 offset:27648
    v_mfma_f32_16x16x32_bf16 v[24:27], v[44:47], v[92:95], v[24:27]
    ds_read_b128 v[68:71], v2 offset:28672
    s_waitcnt lgkmcnt(4)
    v_mfma_f32_16x16x32_bf16 v[28:31], v[48:51], v[92:95], v[28:31]
    ds_read_b128 v[72:75], v2 offset:29696
    v_mfma_f32_16x16x32_bf16 v[32:35], v[52:55], v[92:95], v[32:35]
    ds_read_b128 v[36:39], v2 offset:30720
    s_waitcnt vmcnt(13) lgkmcnt(3)
    v_mfma_f32_16x16x32_bf16 v[16:19], v[56:59], v[96:99], v[16:19]
    ds_read_b128 v[40:43], v2 offset:31744
    v_mfma_f32_16x16x32_bf16 v[20:23], v[60:63], v[96:99], v[20:23]
    buffer_load_dwordx4 v[92:95], v2, s[24:27], s61 offen offset:3072 sc1
    ds_read_b128 v[44:47], v2 offset:32768
    v_mfma_f32_16x16x32_bf16 v[24:27], v[64:67], v[96:99], v[24:27]
    ds_read_b128 v[48:51], v2 offset:33792
    s_waitcnt lgkmcnt(4)
    v_mfma_f32_16x16x32_bf16 v[28:31], v[68:71], v[96:99], v[28:31]
    ds_read_b128 v[52:55], v2 offset:34816
    v_mfma_f32_16x16x32_bf16 v[32:35], v[72:75], v[96:99], v[32:35]
    ds_read_b128 v[56:59], v2 offset:35840
    s_waitcnt vmcnt(13) lgkmcnt(3)
    v_mfma_f32_16x16x32_bf16 v[16:19], v[36:39], v[100:103], v[16:19]
    ds_read_b128 v[60:63], v2 offset:36864
    v_mfma_f32_16x16x32_bf16 v[20:23], v[40:43], v[100:103], v[20:23]
    buffer_load_dwordx2 v[96:97], v6, s[24:27], s62 offen offset:2048 sc1
    buffer_load_dwordx2 v[98:99], v6, s[24:27], s62 offen offset:2176 sc1
    ds_read_b128 v[64:67], v2 offset:37888
    v_mfma_f32_16x16x32_bf16 v[24:27], v[44:47], v[100:103], v[24:27]
    ds_read_b128 v[68:71], v2 offset:38912
    s_waitcnt lgkmcnt(4)
    v_mfma_f32_16x16x32_bf16 v[28:31], v[48:51], v[100:103], v[28:31]
    ds_read_b128 v[72:75], v2 offset:39936
    v_mfma_f32_16x16x32_bf16 v[32:35], v[52:55], v[100:103], v[32:35]
    ds_read_b128 v[36:39], v2 offset:40960
    s_waitcnt vmcnt(14) lgkmcnt(3)
    v_mfma_f32_16x16x32_bf16 v[16:19], v[56:59], v[104:107], v[16:19]
    ds_read_b128 v[40:43], v2 offset:41984
    v_mfma_f32_16x16x32_bf16 v[20:23], v[60:63], v[104:107], v[20:23]
    buffer_load_dwordx2 v[100:101], v6, s[24:27], s62 offen offset:3072 sc1
    buffer_load_dwordx2 v[102:103], v6, s[24:27], s62 offen offset:3200 sc1
    ds_read_b128 v[44:47], v2 offset:43008
    v_mfma_f32_16x16x32_bf16 v[24:27], v[64:67], v[104:107], v[24:27]
    ds_read_b128 v[48:51], v2 offset:44032
    s_waitcnt lgkmcnt(4)
    v_mfma_f32_16x16x32_bf16 v[28:31], v[68:71], v[104:107], v[28:31]
    ds_read_b128 v[52:55], v2 offset:45056
    v_mfma_f32_16x16x32_bf16 v[32:35], v[72:75], v[104:107], v[32:35]
    ds_read_b128 v[56:59], v2 offset:46080
    s_waitcnt vmcnt(14) lgkmcnt(3)
    v_mfma_f32_16x16x32_bf16 v[16:19], v[36:39], v[108:111], v[16:19]
    ds_read_b128 v[60:63], v2 offset:47104
    v_mfma_f32_16x16x32_bf16 v[20:23], v[40:43], v[108:111], v[20:23]
    ds_read_b128 v[64:67], v2 offset:48128
    v_mfma_f32_16x16x32_bf16 v[24:27], v[44:47], v[108:111], v[24:27]
    ds_read_b128 v[68:71], v2 offset:49152
    s_waitcnt lgkmcnt(4)
    v_mfma_f32_16x16x32_bf16 v[28:31], v[48:51], v[108:111], v[28:31]
    ds_read_b128 v[72:75], v2 offset:50176
    v_mfma_f32_16x16x32_bf16 v[32:35], v[52:55], v[108:111], v[32:35]
    ds_read_b128 v[36:39], v3 offset:0
    s_waitcnt vmcnt(12) lgkmcnt(3)
    v_mfma_f32_16x16x32_bf16 v[16:19], v[56:59], v[112:115], v[16:19]
    ds_read_b128 v[40:43], v3 offset:1024
    v_mfma_f32_16x16x32_bf16 v[20:23], v[60:63], v[112:115], v[20:23]
    ds_read_b128 v[44:47], v3 offset:2048
    v_mfma_f32_16x16x32_bf16 v[24:27], v[64:67], v[112:115], v[24:27]
    ds_read_b128 v[48:51], v3 offset:3072
    s_waitcnt lgkmcnt(4)
    v_mfma_f32_16x16x32_bf16 v[28:31], v[68:71], v[112:115], v[28:31]
    ds_read_b128 v[52:55], v3 offset:4096
    v_mfma_f32_16x16x32_bf16 v[32:35], v[72:75], v[112:115], v[32:35]
    ds_read_b128 v[56:59], v3 offset:5120
    s_waitcnt vmcnt(11) lgkmcnt(3)
    v_mfma_f32_16x16x32_bf16 v[16:19], v[36:39], v[116:119], v[16:19]
    ds_read_b128 v[60:63], v3 offset:6144
    v_mfma_f32_16x16x32_bf16 v[20:23], v[40:43], v[116:119], v[20:23]
    ds_read_b128 v[64:67], v3 offset:7168
    v_mfma_f32_16x16x32_bf16 v[24:27], v[44:47], v[116:119], v[24:27]
    ds_read_b128 v[68:71], v3 offset:8192
    s_waitcnt lgkmcnt(4)
    v_mfma_f32_16x16x32_bf16 v[28:31], v[48:51], v[116:119], v[28:31]
    ds_read_b128 v[72:75], v3 offset:9216
    v_mfma_f32_16x16x32_bf16 v[32:35], v[52:55], v[116:119], v[32:35]
    ds_read_b128 v[36:39], v3 offset:10240
    s_waitcnt vmcnt(10) lgkmcnt(3)
    v_mfma_f32_16x16x32_bf16 v[16:19], v[56:59], v[120:123], v[16:19]
    ds_read_b128 v[40:43], v3 offset:11264
    v_mfma_f32_16x16x32_bf16 v[20:23], v[60:63], v[120:123], v[20:23]
    ds_read_b128 v[44:47], v3 offset:12288
    v_mfma_f32_16x16x32_bf16 v[24:27], v[64:67], v[120:123], v[24:27]
    ds_read_b128 v[48:51], v3 offset:13312
    s_waitcnt lgkmcnt(4)
    v_mfma_f32_16x16x32_bf16 v[28:31], v[68:71], v[120:123], v[28:31]
    ds_read_b128 v[52:55], v3 offset:14336
    v_mfma_f32_16x16x32_bf16 v[32:35], v[72:75], v[120:123], v[32:35]
    ds_read_b128 v[56:59], v3 offset:15360
    s_waitcnt vmcnt(9) lgkmcnt(3)
    v_mfma_f32_16x16x32_bf16 v[16:19], v[36:39], v[124:127], v[16:19]
    ds_read_b128 v[60:63], v3 offset:16384
    v_mfma_f32_16x16x32_bf16 v[20:23], v[40:43], v[124:127], v[20:23]
    ds_read_b128 v[64:67], v3 offset:17408
    v_mfma_f32_16x16x32_bf16 v[24:27], v[44:47], v[124:127], v[24:27]
    ds_read_b128 v[68:71], v3 offset:18432
    s_waitcnt lgkmcnt(4)
    v_mfma_f32_16x16x32_bf16 v[28:31], v[48:51], v[124:127], v[28:31]
    ds_read_b128 v[72:75], v3 offset:19456
    v_mfma_f32_16x16x32_bf16 v[32:35], v[52:55], v[124:127], v[32:35]
    ds_read_b128 v[36:39], v3 offset:20480
    s_waitcnt vmcnt(8) lgkmcnt(3)
    v_mfma_f32_16x16x32_bf16 v[16:19], v[56:59], v[76:79], v[16:19]
    ds_read_b128 v[40:43], v3 offset:21504
    v_mfma_f32_16x16x32_bf16 v[20:23], v[60:63], v[76:79], v[20:23]
    ds_read_b128 v[44:47], v3 offset:22528
    v_mfma_f32_16x16x32_bf16 v[24:27], v[64:67], v[76:79], v[24:27]
    ds_read_b128 v[48:51], v3 offset:23552
    s_waitcnt lgkmcnt(4)
    v_mfma_f32_16x16x32_bf16 v[28:31], v[68:71], v[76:79], v[28:31]
    ds_read_b128 v[52:55], v3 offset:24576
    v_mfma_f32_16x16x32_bf16 v[32:35], v[72:75], v[76:79], v[32:35]
    ds_read_b128 v[56:59], v3 offset:25600
    s_waitcnt vmcnt(7) lgkmcnt(3)
    v_mfma_f32_16x16x32_bf16 v[16:19], v[36:39], v[80:83], v[16:19]
    ds_read_b128 v[60:63], v3 offset:26624
    v_mfma_f32_16x16x32_bf16 v[20:23], v[40:43], v[80:83], v[20:23]
    ds_read_b128 v[64:67], v3 offset:27648
    v_mfma_f32_16x16x32_bf16 v[24:27], v[44:47], v[80:83], v[24:27]
    ds_read_b128 v[68:71], v3 offset:28672
    s_waitcnt lgkmcnt(4)
    v_mfma_f32_16x16x32_bf16 v[28:31], v[48:51], v[80:83], v[28:31]
    ds_read_b128 v[72:75], v3 offset:29696
    v_mfma_f32_16x16x32_bf16 v[32:35], v[52:55], v[80:83], v[32:35]
    ds_read_b128 v[36:39], v3 offset:30720
    s_waitcnt vmcnt(6) lgkmcnt(3)
    v_mfma_f32_16x16x32_bf16 v[16:19], v[56:59], v[84:87], v[16:19]
    ds_read_b128 v[40:43], v3 offset:31744
    v_mfma_f32_16x16x32_bf16 v[20:23], v[60:63], v[84:87], v[20:23]
    ds_read_b128 v[44:47], v3 offset:32768
    v_mfma_f32_16x16x32_bf16 v[24:27], v[64:67], v[84:87], v[24:27]
    ds_read_b128 v[48:51], v3 offset:33792
    s_waitcnt lgkmcnt(4)
    v_mfma_f32_16x16x32_bf16 v[28:31], v[68:71], v[84:87], v[28:31]
    ds_read_b128 v[52:55], v3 offset:34816
    v_mfma_f32_16x16x32_bf16 v[32:35], v[72:75], v[84:87], v[32:35]
    ds_read_b128 v[56:59], v3 offset:35840
    s_waitcnt vmcnt(5) lgkmcnt(3)
    v_mfma_f32_16x16x32_bf16 v[16:19], v[36:39], v[88:91], v[16:19]
    ds_read_b128 v[60:63], v3 offset:36864
    v_mfma_f32_16x16x32_bf16 v[20:23], v[40:43], v[88:91], v[20:23]
    ds_read_b128 v[64:67], v3 offset:37888
    v_mfma_f32_16x16x32_bf16 v[24:27], v[44:47], v[88:91], v[24:27]
    ds_read_b128 v[68:71], v3 offset:38912
    s_waitcnt lgkmcnt(4)
    v_mfma_f32_16x16x32_bf16 v[28:31], v[48:51], v[88:91], v[28:31]
    ds_read_b128 v[72:75], v3 offset:39936
    v_mfma_f32_16x16x32_bf16 v[32:35], v[52:55], v[88:91], v[32:35]
    ds_read_b128 v[36:39], v3 offset:40960
    s_waitcnt vmcnt(4) lgkmcnt(3)
    v_mfma_f32_16x16x32_bf16 v[16:19], v[56:59], v[92:95], v[16:19]
    ds_read_b128 v[40:43], v3 offset:41984
    v_mfma_f32_16x16x32_bf16 v[20:23], v[60:63], v[92:95], v[20:23]
    ds_read_b128 v[44:47], v3 offset:43008
    v_mfma_f32_16x16x32_bf16 v[24:27], v[64:67], v[92:95], v[24:27]
    ds_read_b128 v[48:51], v3 offset:44032
    s_waitcnt lgkmcnt(4)
    v_mfma_f32_16x16x32_bf16 v[28:31], v[68:71], v[92:95], v[28:31]
    ds_read_b128 v[52:55], v3 offset:45056
    v_mfma_f32_16x16x32_bf16 v[32:35], v[72:75], v[92:95], v[32:35]
    ds_read_b128 v[56:59], v3 offset:46080
    s_waitcnt vmcnt(2) lgkmcnt(3)
    v_mfma_f32_16x16x32_bf16 v[16:19], v[36:39], v[96:99], v[16:19]
    ds_read_b128 v[60:63], v3 offset:47104
    v_mfma_f32_16x16x32_bf16 v[20:23], v[40:43], v[96:99], v[20:23]
    ds_read_b128 v[64:67], v3 offset:48128
    v_mfma_f32_16x16x32_bf16 v[24:27], v[44:47], v[96:99], v[24:27]
    ds_read_b128 v[68:71], v3 offset:49152
    s_waitcnt lgkmcnt(4)
    v_mfma_f32_16x16x32_bf16 v[28:31], v[48:51], v[96:99], v[28:31]
    ds_read_b128 v[72:75], v3 offset:50176
    v_mfma_f32_16x16x32_bf16 v[32:35], v[52:55], v[96:99], v[32:35]
    s_waitcnt vmcnt(0) lgkmcnt(2)
    v_mfma_f32_16x16x32_bf16 v[16:19], v[56:59], v[100:103], v[16:19]
    v_mfma_f32_16x16x32_bf16 v[20:23], v[60:63], v[100:103], v[20:23]
    v_mfma_f32_16x16x32_bf16 v[24:27], v[64:67], v[100:103], v[24:27]
    s_waitcnt lgkmcnt(0)
    v_mfma_f32_16x16x32_bf16 v[28:31], v[68:71], v[100:103], v[28:31]
    v_mfma_f32_16x16x32_bf16 v[32:35], v[72:75], v[100:103], v[32:35]
    s_nop 2
    v_cvt_pk_bf16_f32 v56, v16, v17
    v_cvt_pk_bf16_f32 v57, v18, v19
    v_cvt_pk_bf16_f32 v58, v20, v21
    v_cvt_pk_bf16_f32 v59, v22, v23
    buffer_store_dwordx4 v[56:59], v2, s[24:27], s52 offen offset:0 sc1
    v_cvt_pk_bf16_f32 v60, v24, v25
    v_cvt_pk_bf16_f32 v61, v26, v27
    v_cvt_pk_bf16_f32 v62, v28, v29
    v_cvt_pk_bf16_f32 v63, v30, v31
    buffer_store_dwordx4 v[60:63], v2, s[24:27], s52 offen offset:1024 sc1
    v_cvt_pk_bf16_f32 v64, v32, v33
    v_cvt_pk_bf16_f32 v65, v34, v35
    buffer_store_dwordx2 v[64:65], v4, s[24:27], s53 offen sc1
    v_pk_mul_f32 v[54:55], v[16:17], v[16:17]
    v_pk_add_f32 v[52:53], v[16:17], v[18:19]
    v_pk_fma_f32 v[54:55], v[18:19], v[18:19], v[54:55]
    v_pk_fma_f32 v[54:55], v[20:21], v[20:21], v[54:55]
    v_pk_add_f32 v[52:53], v[52:53], v[20:21]
    v_pk_fma_f32 v[54:55], v[22:23], v[22:23], v[54:55]
    v_pk_add_f32 v[52:53], v[52:53], v[22:23]
    v_pk_fma_f32 v[54:55], v[24:25], v[24:25], v[54:55]
    v_pk_add_f32 v[52:53], v[52:53], v[24:25]
    v_pk_fma_f32 v[54:55], v[26:27], v[26:27], v[54:55]
    v_pk_add_f32 v[52:53], v[52:53], v[26:27]
    v_pk_fma_f32 v[54:55], v[28:29], v[28:29], v[54:55]
    v_pk_add_f32 v[52:53], v[52:53], v[28:29]
    v_pk_fma_f32 v[54:55], v[30:31], v[30:31], v[54:55]
    v_pk_add_f32 v[52:53], v[52:53], v[30:31]
    v_pk_fma_f32 v[54:55], v[32:33], v[32:33], v[54:55]
    v_pk_add_f32 v[52:53], v[52:53], v[32:33]
    v_pk_fma_f32 v[54:55], v[34:35], v[34:35], v[54:55]
    v_pk_add_f32 v[52:53], v[52:53], v[34:35]
    v_add_f32 v52, v52, v53
    v_add_f32 v54, v54, v55
    s_nop 1
    v_permlane16_swap_b32 v52, v54
    v_add_f32 v52, v52, v54
    v_mov_b32 v53, v52
    s_nop 1
    v_permlane32_swap_b32 v52, v53
    v_add_f32 v52, v52, v53
    s_mov_b32 exec_hi, 0
    buffer_store_dword v52, v5, s[24:27], s54 offen sc1
    s_mov_b64 exec, -1
    s_branch L_C_pub
L_C_help:
    s_and_b32 s52, s46, 1
    s_mul_i32 s52, s52, 24
    s_lshr_b32 s53, s46, 1
    s_add_u32 s52, s52, s53
    s_mul_i32 s52, s52, 5120
    s_add_u32 s52, s52, s69
    s_add_u32 s52, s52, 0
    s_mul_i32 s53, s46, 5120
    s_add_u32 m0, s53, 122880
    s_nop 0
    buffer_load_dwordx4 v2, s[24:27], s52 offen offset:0 sc1 lds
    buffer_load_dwordx4 v2, s[24:27], s52 offen offset:1024 sc1 lds
    buffer_load_dwordx4 v2, s[24:27], s52 offen offset:2048 sc1 lds
    buffer_load_dwordx4 v2, s[24:27], s52 offen offset:3072 sc1 lds
    s_add_u32 m0, s53, 126976
    s_add_u32 s52, s52, 4096
    buffer_load_dwordx4 v2, s[24:27], s52 offen sc1 lds
    s_sub_u32 s52, s52, 14336
    s_add_u32 m0, s53, 102400
    s_nop 0
    buffer_load_dwordx4 v2, s[24:27], s52 offen offset:0 sc1 lds
    buffer_load_dwordx4 v2, s[24:27], s52 offen offset:1024 sc1 lds
    buffer_load_dwordx4 v2, s[24:27], s52 offen offset:2048 sc1 lds
    buffer_load_dwordx4 v2, s[24:27], s52 offen offset:3072 sc1 lds
    s_add_u32 m0, s53, 106496
    s_add_u32 s52, s52, 4096
    buffer_load_dwordx4 v2, s[24:27], s52 offen sc1 lds
    s_add_u32 s52, s52, 21504
    s_add_u32 m0, s53, 81920
    s_nop 0
    buffer_load_dwordx4 v2, s[24:27], s52 offen offset:0 sc1 lds
    buffer_load_dwordx4 v2, s[24:27], s52 offen offset:1024 sc1 lds
    buffer_load_dwordx4 v2, s[24:27], s52 offen offset:2048 sc1 lds
    buffer_load_dwordx4 v2, s[24:27], s52 offen offset:3072 sc1 lds
    s_add_u32 m0, s53, 86016
    s_add_u32 s52, s52, 4096
    buffer_load_dwordx4 v2, s[24:27], s52 offen sc1 lds
Lw2_46:
    s_and_b32 s52, s46, 1
    s_mul_i32 s76, s52, 24
    s_lshr_b32 s52, s46, 1
    s_add_u32 s76, s76, s52
    s_mul_i32 s76, s76, 5120
    s_add_u32 s76, s76, s69
    s_add_u32 s76, s76, 35840
    v_mov_b32 v16, 0x3f803f80
    v_mov_b32 v17, 0x3f803f80
    v_mov_b32 v18, 0x3f803f80
    v_mov_b32 v19, 0x3f803f80
    s_nop 1
    v_mfma_f32_16x16x32_bf16 v[88:91], v[136:139], v[16:19], 0
    v_mfma_f32_16x16x32_bf16 v[92:95], v[176:179], v[16:19], 0
    v_mfma_f32_16x16x32_bf16 v[96:99], v[216:219], v[16:19], 0
    v_mfma_f32_16x16x32_bf16 v[88:91], v[140:143], v[16:19], v[88:91]
    v_mfma_f32_16x16x32_bf16 v[92:95], v[180:183], v[16:19], v[92:95]
    v_mfma_f32_16x16x32_bf16 v[96:99], v[220:223], v[16:19], v[96:99]
    v_mfma_f32_16x16x32_bf16 v[88:91], v[144:147], v[16:19], v[88:91]
    v_mfma_f32_16x16x32_bf16 v[92:95], v[184:187], v[16:19], v[92:95]
    v_mfma_f32_16x16x32_bf16 v[96:99], v[224:227], v[16:19], v[96:99]
    v_mfma_f32_16x16x32_bf16 v[88:91], v[148:151], v[16:19], v[88:91]
    v_mfma_f32_16x16x32_bf16 v[92:95], v[188:191], v[16:19], v[92:95]
    v_mfma_f32_16x16x32_bf16 v[96:99], v[228:231], v[16:19], v[96:99]
    v_mfma_f32_16x16x32_bf16 v[88:91], v[152:155], v[16:19], v[88:91]
    v_mfma_f32_16x16x32_bf16 v[92:95], v[192:195], v[16:19], v[92:95]
    v_mfma_f32_16x16x32_bf16 v[96:99], v[232:235], v[16:19], v[96:99]
    v_mfma_f32_16x16x32_bf16 v[88:91], v[156:159], v[16:19], v[88:91]
    v_mfma_f32_16x16x32_bf16 v[92:95], v[196:199], v[16:19], v[92:95]
    v_mfma_f32_16x16x32_bf16 v[96:99], v[236:239], v[16:19], v[96:99]
    v_mfma_f32_16x16x32_bf16 v[88:91], v[160:163], v[16:19], v[88:91]
    v_mfma_f32_16x16x32_bf16 v[92:95], v[200:203], v[16:19], v[92:95]
    v_mfma_f32_16x16x32_bf16 v[96:99], v[240:243], v[16:19], v[96:99]
    v_mfma_f32_16x16x32_bf16 v[88:91], v[164:167], v[16:19], v[88:91]
    v_mfma_f32_16x16x32_bf16 v[92:95], v[204:207], v[16:19], v[92:95]
    v_mfma_f32_16x16x32_bf16 v[96:99], v[244:247], v[16:19], v[96:99]
    v_mfma_f32_16x16x32_bf16 v[88:91], v[168:171], v[16:19], v[88:91]
    v_mfma_f32_16x16x32_bf16 v[92:95], v[208:211], v[16:19], v[92:95]
    v_mfma_f32_16x16x32_bf16 v[96:99], v[248:251], v[16:19], v[96:99]
    v_mfma_f32_16x16x32_bf16 v[88:91], v[172:175], v[16:19], v[88:91]
    v_mfma_f32_16x16x32_bf16 v[92:95], v[212:215], v[16:19], v[92:95]
    v_mfma_f32_16x16x32_bf16 v[96:99], v[252:255], v[16:19], v[96:99]
    s_cmp_lg_u32 s46, 7
    s_cbranch_scc1 Lpn_47
    v_and_b32 v10, 31, v1
    v_lshlrev_b32 v10, 5, v10
    s_lshl_b32 s52, s44, 10
    s_add_u32 s52, s52, 21069824
    s_mov_b32 s94, 0
Lpoll_48:
    buffer_load_dwordx2 v[12:13], v10, s[24:27], s52 offen sc1
    s_add_u32 s94, s94, 1
    s_waitcnt vmcnt(0)
    v_cmp_ne_u64 vcc, s[48:49], v[12:13]
    s_cbranch_vccz Lpolle_49
    s_cmp_le_u32 s94, 0x40000
    s_cbranch_scc1 Lpoll_48
Lpolle_49:
Lpn_47:
    s_barrier
L_C_pub:
    s_lshl_b32 s52, s96, 8
    s_lshl_b32 s53, s51, 5
    s_add_u32 s52, s52, s53
    s_add_u32 s52, s52, 21102592
    v_mov_b32 v10, s48
    v_mov_b32 v11, s49
    v_lshlrev_b32 v12, 3, v1
    s_cmp_lg_u32 s46, 7
    s_waitcnt vmcnt(0)
    s_barrier
    s_cbranch_scc1 Lff_50
    s_mov_b64 exec, 0xf
    buffer_store_dwordx2 v[10:11], v12, s[24:27], s52 offen sc1
    s_mov_b64 exec, -1
Lff_50:
    s_cmp_ge_u32 s46, 4
    s_cbranch_scc1 Lce_51
    s_and_b32 s52, s46, 1
    s_mul_i32 s76, s52, 24
    s_lshr_b32 s52, s46, 1
    s_add_u32 s76, s76, s52
    s_mul_i32 s76, s76, 5120
    s_add_u32 s76, s76, s69
    s_add_u32 s76, s76, 35840
Lce_51:
    s_cmp_ge_u32 s46, 2
    s_cbranch_scc1 Lw2_52
    s_and_b32 s52, s46, 1
    s_mul_i32 s52, s52, 24
    s_lshr_b32 s53, s46, 1
    s_add_u32 s52, s52, s53
    s_mul_i32 s52, s52, 5120
    s_add_u32 s52, s52, s69
    s_add_u32 s52, s52, 20480
    s_mul_i32 s53, s46, 5120
    s_add_u32 m0, s53, 92160
    s_nop 0
    buffer_load_dwordx4 v2, s[24:27], s52 offen offset:0 sc1 lds
    buffer_load_dwordx4 v2, s[24:27], s52 offen offset:1024 sc1 lds
    buffer_load_dwordx4 v2, s[24:27], s52 offen offset:2048 sc1 lds
    buffer_load_dwordx4 v2, s[24:27], s52 offen offset:3072 sc1 lds
    s_add_u32 m0, s53, 96256
    s_add_u32 s52, s52, 4096
    buffer_load_dwordx4 v2, s[24:27], s52 offen sc1 lds
Lw2_52:
    s_and_b32 s55, s46, 3
    s_lshr_b32 s56, s46, 2
    v_lshrrev_b32 v20, 4, v1
    v_lshlrev_b32 v21, 3, v20
    s_and_b32 s53, s46, 2
    s_lshl_b32 s53, s53, 5
    s_add_u32 s53, s53, s97
    buffer_load_dwordx2 v[86:87], v21, s[40:43], s53 offen
    buffer_load_dwordx2 v[112:113], v21, s[40:43], s53 offen offset:32
    buffer_load_dwordx2 v[114:115], v21, s[40:43], s97 offen offset:128
    s_and_b32 s52, s46, 1
    s_lshl_b32 s52, s52, 1
    s_add_u32 s52, s52, s95
    s_mul_i32 s52, s52, 20480
    s_add_u32 s52, s52, 11534336
    s_lshl_b32 s53, s51, 9
    s_add_u32 s53, s53, s52
    s_add_u32 s53, s53, 16384
    s_lshl_b32 s54, s51, 11
    s_add_u32 s52, s52, s54
    s_and_b32 s54, s46, 2
    s_lshl_b32 s54, s54, 9
    s_add_u32 s52, s52, s54
    v_lshlrev_b32 v7, 3, v1
    s_cmp_lt_u32 s46, 4
    s_cbranch_scc1 Ldh_53
    buffer_load_dwordx4 v[116:119], v2, s[24:27], s52 offen sc1
    buffer_load_dwordx2 v[124:125], v7, s[24:27], s53 offen sc1
    s_add_u32 s52, s52, 20480
    s_add_u32 s53, s53, 20480
    buffer_load_dwordx4 v[120:123], v2, s[24:27], s52 offen sc1
    buffer_load_dwordx2 v[126:127], v7, s[24:27], s53 offen sc1
Ldh_53:
    s_cmp_ge_u32 s46, 4
    s_cbranch_scc1 Lcs_54
    v_mov_b32 v16, 0x3f803f80
    v_mov_b32 v17, 0x3f803f80
    v_mov_b32 v18, 0x3f803f80
    v_mov_b32 v19, 0x3f803f80
    s_nop 1
    v_mfma_f32_16x16x32_bf16 v[88:91], v[136:139], v[16:19], 0
    v_mfma_f32_16x16x32_bf16 v[92:95], v[176:179], v[16:19], 0
    v_mfma_f32_16x16x32_bf16 v[96:99], v[216:219], v[16:19], 0
    v_mfma_f32_16x16x32_bf16 v[88:91], v[140:143], v[16:19], v[88:91]
    v_mfma_f32_16x16x32_bf16 v[92:95], v[180:183], v[16:19], v[92:95]
    v_mfma_f32_16x16x32_bf16 v[96:99], v[220:223], v[16:19], v[96:99]
    v_mfma_f32_16x16x32_bf16 v[88:91], v[144:147], v[16:19], v[88:91]
    v_mfma_f32_16x16x32_bf16 v[92:95], v[184:187], v[16:19], v[92:95]
    v_mfma_f32_16x16x32_bf16 v[96:99], v[224:227], v[16:19], v[96:99]
    v_mfma_f32_16x16x32_bf16 v[88:91], v[148:151], v[16:19], v[88:91]
    v_mfma_f32_16x16x32_bf16 v[92:95], v[188:191], v[16:19], v[92:95]
    v_mfma_f32_16x16x32_bf16 v[96:99], v[228:231], v[16:19], v[96:99]
    v_mfma_f32_16x16x32_bf16 v[88:91], v[152:155], v[16:19], v[88:91]
    v_mfma_f32_16x16x32_bf16 v[92:95], v[192:195], v[16:19], v[92:95]
    v_mfma_f32_16x16x32_bf16 v[96:99], v[232:235], v[16:19], v[96:99]
    v_mfma_f32_16x16x32_bf16 v[88:91], v[156:159], v[16:19], v[88:91]
    v_mfma_f32_16x16x32_bf16 v[92:95], v[196:199], v[16:19], v[92:95]
    v_mfma_f32_16x16x32_bf16 v[96:99], v[236:239], v[16:19], v[96:99]
    v_mfma_f32_16x16x32_bf16 v[88:91], v[160:163], v[16:19], v[88:91]
    v_mfma_f32_16x16x32_bf16 v[92:95], v[200:203], v[16:19], v[92:95]
    v_mfma_f32_16x16x32_bf16 v[96:99], v[240:243], v[16:19], v[96:99]
    v_mfma_f32_16x16x32_bf16 v[88:91], v[164:167], v[16:19], v[88:91]
    v_mfma_f32_16x16x32_bf16 v[92:95], v[204:207], v[16:19], v[92:95]
    v_mfma_f32_16x16x32_bf16 v[96:99], v[244:247], v[16:19], v[96:99]
    v_mfma_f32_16x16x32_bf16 v[88:91], v[168:171], v[16:19], v[88:91]
    v_mfma_f32_16x16x32_bf16 v[92:95], v[208:211], v[16:19], v[92:95]
    v_mfma_f32_16x16x32_bf16 v[96:99], v[248:251], v[16:19], v[96:99]
    v_mfma_f32_16x16x32_bf16 v[88:91], v[172:175], v[16:19], v[88:91]
    v_mfma_f32_16x16x32_bf16 v[92:95], v[212:215], v[16:19], v[92:95]
    v_mfma_f32_16x16x32_bf16 v[96:99], v[252:255], v[16:19], v[96:99]
Lcs_54:
    v_lshlrev_b32 v22, 4, v20
    s_mul_i32 s52, s46, 192
    s_add_u32 s52, s52, 90112
    v_add_u32 v23, s52, v22
    s_xor_b32 s52, s46, 4
    s_mul_i32 s52, s52, 192
    s_add_u32 s52, s52, 90112
    v_add_u32 v22, s52, v22
    s_mov_b32 exec_lo, 0x00010001
    s_mov_b32 exec_hi, 0x00010001
    ds_write_b128 v23, v[88:91] offset:0
    ds_write_b128 v23, v[92:95] offset:64
    ds_write_b128 v23, v[96:99] offset:128
    s_mov_b64 exec, -1
    s_mul_i32 s52, s56, 49152
    v_add_u32 v3, s52, v2
    s_mul_i32 s52, s56, -32768
    s_add_u32 s52, s52, 40960
    v_add_u32 v4, s52, v2
    v_lshlrev_b32 v7, 3, v1
    s_mul_i32 s52, s56, 43008
    s_add_u32 s52, s52, 16384
    v_add_u32 v5, s52, v7
    s_mul_i32 s52, s56, -38912
    s_add_u32 s52, s52, 57344
    v_add_u32 v6, s52, v7
    s_mul_i32 s58, s55, 20480
    s_add_u32 s57, s95, s55
    s_mul_i32 s57, s57, 20480
    s_add_u32 s57, s57, 11534336
    s_lshl_b32 s52, s56, 13
    s_add_u32 s60, s57, s52
    s_add_u32 s61, s58, s52
    s_cmp_lg_u32 s46, 7
    s_cbranch_scc1 Lpn_55
    v_and_b32 v10, 7, v1
    v_lshlrev_b32 v10, 5, v10
    s_lshl_b32 s52, s96, 8
    s_add_u32 s52, s52, 21102592
    s_mov_b32 s94, 0
Lpoll_56:
    buffer_load_dwordx2 v[12:13], v10, s[24:27], s52 offen sc1
    s_add_u32 s94, s94, 1
    s_waitcnt vmcnt(0)
    v_cmp_ne_u64 vcc, s[48:49], v[12:13]
    s_cbranch_vccz Lpolle_57
    s_cmp_le_u32 s94, 0x40000
    s_cbranch_scc1 Lpoll_56
Lpolle_57:
Lpn_55:
    s_waitcnt lgkmcnt(0)
    s_barrier
    s_add_u32 m0, s61, 0
    s_add_u32 s53, s60, 0
    buffer_load_dwordx4 v2, s[24:27], s53 offen sc1 lds
    s_add_u32 m0, s61, 1024
    s_add_u32 s53, s60, 1024
    buffer_load_dwordx4 v2, s[24:27], s53 offen sc1 lds
    s_add_u32 m0, s61, 2048
    s_add_u32 s53, s60, 2048
    buffer_load_dwordx4 v2, s[24:27], s53 offen sc1 lds
    s_add_u32 m0, s61, 3072
    s_add_u32 s53, s60, 3072
    buffer_load_dwordx4 v2, s[24:27], s53 offen sc1 lds
    ds_read_b128 v[24:27], v22 offset:0
    ds_read_b128 v[28:31], v22 offset:64
    ds_read_b128 v[32:35], v22 offset:128
    s_waitcnt lgkmcnt(0)
    v_pk_add_f32 v[88:89], v[88:89], v[24:25]
    v_pk_add_f32 v[90:91], v[90:91], v[26:27]
    v_pk_add_f32 v[92:93], v[92:93], v[28:29]
    v_pk_add_f32 v[94:95], v[94:95], v[30:31]
    v_pk_add_f32 v[96:97], v[96:97], v[32:33]
    v_pk_add_f32 v[98:99], v[98:99], v[34:35]
    v_add_u32 v8, s61, v2
    s_xor_b32 s52, s56, 1
    s_lshl_b32 s52, s52, 13
    s_add_u32 s52, s52, s58
    v_add_u32 v9, s52, v2
    s_lshl_b32 s52, s56, 8
    s_add_u32 s52, s52, 81920
    v_lshlrev_b32 v7, 2, v1
    v_add_u32 v7, s52, v7
    v_bfe_u32 v14, v1, 4, 1
    v_mul_u32_u24 v14, 49152, v14
    v_lshrrev_b32 v0, 5, v1
    v_lshl_add_u32 v14, v0, 8, v14
    v_and_b32 v0, 15, v1
    v_lshl_add_u32 v14, v0, 4, v14
    s_lshl_b32 s52, s56, 1
    s_add_u32 s52, s52, s95
    s_mul_i32 s59, s52, 49152
    s_mul_i32 s53, s51, 6144
    s_add_u32 s59, s59, s53
    s_mul_i32 s53, s55, 1536
    s_add_u32 s59, s59, s53
    s_add_u32 s59, s59, 14680064
    s_waitcnt vmcnt(2)
    s_barrier
    ds_read_b128 v[64:67], v3 offset:0
    ds_read_b128 v[68:71], v3 offset:20480
    ds_read_b128 v[72:75], v4 offset:0
    ds_read_b128 v[76:79], v4 offset:20480
    s_waitcnt lgkmcnt(2)
    v_mfma_f32_16x16x32_bf16 v[16:19], v[136:139], v[64:67], 0
    v_mfma_f32_16x16x32_bf16 v[20:23], v[136:139], v[68:71], 0
    v_mfma_f32_16x16x32_bf16 v[32:35], v[176:179], v[64:67], 0
    v_mfma_f32_16x16x32_bf16 v[36:39], v[176:179], v[68:71], 0
    v_mfma_f32_16x16x32_bf16 v[48:51], v[216:219], v[64:67], 0
    v_mfma_f32_16x16x32_bf16 v[52:55], v[216:219], v[68:71], 0
    s_add_u32 m0, s61, 4096
    s_add_u32 s53, s60, 4096
    buffer_load_dwordx4 v2, s[24:27], s53 offen sc1 lds
    s_add_u32 m0, s61, 5120
    s_add_u32 s53, s60, 5120
    buffer_load_dwordx4 v2, s[24:27], s53 offen sc1 lds
    ds_read_b128 v[64:67], v3 offset:1024
    ds_read_b128 v[68:71], v3 offset:21504
    s_waitcnt lgkmcnt(2)
    v_mfma_f32_16x16x32_bf16 v[24:27], v[136:139], v[72:75], 0
    v_mfma_f32_16x16x32_bf16 v[28:31], v[136:139], v[76:79], 0
    v_mfma_f32_16x16x32_bf16 v[40:43], v[176:179], v[72:75], 0
    v_mfma_f32_16x16x32_bf16 v[44:47], v[176:179], v[76:79], 0
    v_mfma_f32_16x16x32_bf16 v[56:59], v[216:219], v[72:75], 0
    v_mfma_f32_16x16x32_bf16 v[60:63], v[216:219], v[76:79], 0
    s_add_u32 m0, s61, 6144
    s_add_u32 s53, s60, 6144
    buffer_load_dwordx4 v2, s[24:27], s53 offen sc1 lds
    s_add_u32 m0, s61, 7168
    s_add_u32 s53, s60, 7168
    buffer_load_dwordx4 v2, s[24:27], s53 offen sc1 lds
    ds_read_b128 v[72:75], v4 offset:1024
    ds_read_b128 v[76:79], v4 offset:21504
    s_waitcnt lgkmcnt(2)
    v_mfma_f32_16x16x32_bf16 v[16:19], v[140:143], v[64:67], v[16:19]
    v_mfma_f32_16x16x32_bf16 v[20:23], v[140:143], v[68:71], v[20:23]
    v_mfma_f32_16x16x32_bf16 v[32:35], v[180:183], v[64:67], v[32:35]
    v_mfma_f32_16x16x32_bf16 v[36:39], v[180:183], v[68:71], v[36:39]
    v_mfma_f32_16x16x32_bf16 v[48:51], v[220:223], v[64:67], v[48:51]
    v_mfma_f32_16x16x32_bf16 v[52:55], v[220:223], v[68:71], v[52:55]
    s_lshl_b32 s52, s56, 11
    s_add_u32 s52, s52, 16384
    s_add_u32 s53, s57, s52
    s_add_u32 m0, s58, s52
    s_nop 0
    buffer_load_dwordx4 v2, s[24:27], s53 offen sc1 lds
    s_lshl_b32 s52, s56, 11
    s_add_u32 s52, s52, 17408
    s_add_u32 s53, s57, s52
    s_add_u32 m0, s58, s52
    s_nop 0
    buffer_load_dwordx4 v2, s[24:27], s53 offen sc1 lds
    s_waitcnt lgkmcnt(0)
    v_mfma_f32_16x16x32_bf16 v[24:27], v[140:143], v[72:75], v[24:27]
    v_mfma_f32_16x16x32_bf16 v[28:31], v[140:143], v[76:79], v[28:31]
    v_mfma_f32_16x16x32_bf16 v[40:43], v[180:183], v[72:75], v[40:43]
    v_mfma_f32_16x16x32_bf16 v[44:47], v[180:183], v[76:79], v[44:47]
    v_mfma_f32_16x16x32_bf16 v[56:59], v[220:223], v[72:75], v[56:59]
    v_mfma_f32_16x16x32_bf16 v[60:63], v[220:223], v[76:79], v[60:63]
    s_lshl_b32 s52, s96, 12
    s_lshl_b32 s53, s55, 10
    s_add_u32 m0, s53, 81920
    s_add_u32 s53, s52, s53
    s_add_u32 s53, s53, 14417920
    buffer_load_dwordx4 v2, s[24:27], s53 offen sc1 lds
    s_waitcnt vmcnt(5)
    s_barrier
    ds_read_b128 v[64:67], v3 offset:2048
    ds_read_b128 v[68:71], v3 offset:22528
    ds_read_b128 v[72:75], v4 offset:2048
    ds_read_b128 v[76:79], v4 offset:22528
    s_waitcnt lgkmcnt(2)
    v_mfma_f32_16x16x32_bf16 v[16:19], v[144:147], v[64:67], v[16:19]
    v_mfma_f32_16x16x32_bf16 v[20:23], v[144:147], v[68:71], v[20:23]
    v_mfma_f32_16x16x32_bf16 v[32:35], v[184:187], v[64:67], v[32:35]
    v_mfma_f32_16x16x32_bf16 v[36:39], v[184:187], v[68:71], v[36:39]
    v_mfma_f32_16x16x32_bf16 v[48:51], v[224:227], v[64:67], v[48:51]
    v_mfma_f32_16x16x32_bf16 v[52:55], v[224:227], v[68:71], v[52:55]
    s_add_u32 s53, s76, 0
    buffer_load_dwordx4 v[136:139], v2, s[24:27], s53 offen sc1
    ds_read_b128 v[64:67], v3 offset:3072
    ds_read_b128 v[68:71], v3 offset:23552
    s_waitcnt lgkmcnt(2)
    v_mfma_f32_16x16x32_bf16 v[24:27], v[144:147], v[72:75], v[24:27]
    v_mfma_f32_16x16x32_bf16 v[28:31], v[144:147], v[76:79], v[28:31]
    v_mfma_f32_16x16x32_bf16 v[40:43], v[184:187], v[72:75], v[40:43]
    v_mfma_f32_16x16x32_bf16 v[44:47], v[184:187], v[76:79], v[44:47]
    v_mfma_f32_16x16x32_bf16 v[56:59], v[224:227], v[72:75], v[56:59]
    v_mfma_f32_16x16x32_bf16 v[60:63], v[224:227], v[76:79], v[60:63]
    s_add_u32 s53, s76, 1024
    buffer_load_dwordx4 v[176:179], v2, s[24:27], s53 offen sc1
    ds_read_b128 v[72:75], v4 offset:3072
    ds_read_b128 v[76:79], v4 offset:23552
    s_waitcnt lgkmcnt(2)
    v_mfma_f32_16x16x32_bf16 v[16:19], v[148:151], v[64:67], v[16:19]
    v_mfma_f32_16x16x32_bf16 v[20:23], v[148:151], v[68:71], v[20:23]
    v_mfma_f32_16x16x32_bf16 v[32:35], v[188:191], v[64:67], v[32:35]
    v_mfma_f32_16x16x32_bf16 v[36:39], v[188:191], v[68:71], v[36:39]
    v_mfma_f32_16x16x32_bf16 v[48:51], v[228:231], v[64:67], v[48:51]
    v_mfma_f32_16x16x32_bf16 v[52:55], v[228:231], v[68:71], v[52:55]
    s_add_u32 s53, s76, 2048
    buffer_load_dwordx4 v[216:219], v2, s[24:27], s53 offen sc1
    ds_read_b128 v[64:67], v3 offset:4096
    ds_read_b128 v[68:71], v3 offset:24576
    s_waitcnt lgkmcnt(2)
    v_mfma_f32_16x16x32_bf16 v[24:27], v[148:151], v[72:75], v[24:27]
    v_mfma_f32_16x16x32_bf16 v[28:31], v[148:151], v[76:79], v[28:31]
    v_mfma_f32_16x16x32_bf16 v[40:43], v[188:191], v[72:75], v[40:43]
    v_mfma_f32_16x16x32_bf16 v[44:47], v[188:191], v[76:79], v[44:47]
    v_mfma_f32_16x16x32_bf16 v[56:59], v[228:231], v[72:75], v[56:59]
    v_mfma_f32_16x16x32_bf16 v[60:63], v[228:231], v[76:79], v[60:63]
    s_add_u32 s53, s76, 3072
    buffer_load_dwordx4 v[140:143], v2, s[24:27], s53 offen sc1
    ds_read_b128 v[72:75], v4 offset:4096
    ds_read_b128 v[76:79], v4 offset:24576
    s_waitcnt lgkmcnt(2)
    v_mfma_f32_16x16x32_bf16 v[16:19], v[152:155], v[64:67], v[16:19]
    v_mfma_f32_16x16x32_bf16 v[20:23], v[152:155], v[68:71], v[20:23]
    v_mfma_f32_16x16x32_bf16 v[32:35], v[192:195], v[64:67], v[32:35]
    v_mfma_f32_16x16x32_bf16 v[36:39], v[192:195], v[68:71], v[36:39]
    v_mfma_f32_16x16x32_bf16 v[48:51], v[232:235], v[64:67], v[48:51]
    v_mfma_f32_16x16x32_bf16 v[52:55], v[232:235], v[68:71], v[52:55]
    s_add_u32 s53, s76, 4096
    buffer_load_dwordx4 v[180:183], v2, s[24:27], s53 offen sc1
    ds_read_b128 v[64:67], v3 offset:5120
    ds_read_b128 v[68:71], v3 offset:25600
    s_waitcnt lgkmcnt(2)
    v_mfma_f32_16x16x32_bf16 v[24:27], v[152:155], v[72:75], v[24:27]
    v_mfma_f32_16x16x32_bf16 v[28:31], v[152:155], v[76:79], v[28:31]
    v_mfma_f32_16x16x32_bf16 v[40:43], v[192:195], v[72:75], v[40:43]
    v_mfma_f32_16x16x32_bf16 v[44:47], v[192:195], v[76:79], v[44:47]
    v_mfma_f32_16x16x32_bf16 v[56:59], v[232:235], v[72:75], v[56:59]
    v_mfma_f32_16x16x32_bf16 v[60:63], v[232:235], v[76:79], v[60:63]
    s_add_u32 s53, s76, 20480
    buffer_load_dwordx4 v[220:223], v2, s[24:27], s53 offen sc1
    ds_read_b128 v[72:75], v4 offset:5120
    ds_read_b128 v[76:79], v4 offset:25600
    s_waitcnt lgkmcnt(2)
    v_mfma_f32_16x16x32_bf16 v[16:19], v[156:159], v[64:67], v[16:19]
    v_mfma_f32_16x16x32_bf16 v[20:23], v[156:159], v[68:71], v[20:23]
    v_mfma_f32_16x16x32_bf16 v[32:35], v[196:199], v[64:67], v[32:35]
    v_mfma_f32_16x16x32_bf16 v[36:39], v[196:199], v[68:71], v[36:39]
    v_mfma_f32_16x16x32_bf16 v[48:51], v[236:239], v[64:67], v[48:51]
    v_mfma_f32_16x16x32_bf16 v[52:55], v[236:239], v[68:71], v[52:55]
    s_add_u32 s53, s76, 21504
    buffer_load_dwordx4 v[144:147], v2, s[24:27], s53 offen sc1
    s_add_u32 s53, s76, 22528
    buffer_load_dwordx4 v[184:187], v2, s[24:27], s53 offen sc1
    s_waitcnt lgkmcnt(0)
    v_mfma_f32_16x16x32_bf16 v[24:27], v[156:159], v[72:75], v[24:27]
    v_mfma_f32_16x16x32_bf16 v[28:31], v[156:159], v[76:79], v[28:31]
    v_mfma_f32_16x16x32_bf16 v[40:43], v[196:199], v[72:75], v[40:43]
    v_mfma_f32_16x16x32_bf16 v[44:47], v[196:199], v[76:79], v[44:47]
    v_mfma_f32_16x16x32_bf16 v[56:59], v[236:239], v[72:75], v[56:59]
    v_mfma_f32_16x16x32_bf16 v[60:63], v[236:239], v[76:79], v[60:63]
    s_add_u32 s53, s76, 23552
    buffer_load_dwordx4 v[224:227], v2, s[24:27], s53 offen sc1
    s_add_u32 s53, s76, 24576
    buffer_load_dwordx4 v[148:151], v2, s[24:27], s53 offen sc1
    s_waitcnt vmcnt(10)
    s_barrier
    ds_read_b128 v[64:67], v4 offset:6144
    ds_read_b128 v[68:71], v4 offset:26624
    ds_read_b128 v[72:75], v4 offset:7168
    ds_read_b128 v[76:79], v4 offset:27648
    s_waitcnt lgkmcnt(2)
    v_mfma_f32_16x16x32_bf16 v[24:27], v[160:163], v[64:67], v[24:27]
    v_mfma_f32_16x16x32_bf16 v[28:31], v[160:163], v[68:71], v[28:31]
    v_mfma_f32_16x16x32_bf16 v[40:43], v[200:203], v[64:67], v[40:43]
    v_mfma_f32_16x16x32_bf16 v[44:47], v[200:203], v[68:71], v[44:47]
    v_mfma_f32_16x16x32_bf16 v[56:59], v[240:243], v[64:67], v[56:59]
    v_mfma_f32_16x16x32_bf16 v[60:63], v[240:243], v[68:71], v[60:63]
    s_cmp_ge_u32 s46, 2
    s_cbranch_scc1 Ld15_58
    s_add_u32 s53, s76, 40960
    buffer_load_dwordx4 v[188:191], v2, s[24:27], s53 offen sc1
    s_add_u32 s53, s76, 41984
    buffer_load_dwordx4 v[228:231], v2, s[24:27], s53 offen sc1
    s_add_u32 s53, s76, 43008
    buffer_load_dwordx4 v[152:155], v2, s[24:27], s53 offen sc1
    s_add_u32 s53, s76, 44032
    buffer_load_dwordx4 v[192:195], v2, s[24:27], s53 offen sc1
    s_add_u32 s53, s76, 45056
    buffer_load_dwordx4 v[232:235], v2, s[24:27], s53 offen sc1
Ld15_58:
    ds_read2st64_b32 v[100:101], v7 offset0:0 offset1:2
    ds_read2st64_b32 v[102:103], v7 offset0:4 offset1:6
    ds_read2st64_b32 v[104:105], v7 offset0:8 offset1:10
    ds_read2st64_b32 v[106:107], v7 offset0:12 offset1:14
    ds_read2st64_b64 v[64:67], v6 offset0:0 offset1:1
    ds_read2st64_b64 v[68:71], v6 offset0:40 offset1:41
    s_waitcnt lgkmcnt(2)
    v_mfma_f32_16x16x32_bf16 v[24:27], v[164:167], v[72:75], v[24:27]
    v_mfma_f32_16x16x32_bf16 v[28:31], v[164:167], v[76:79], v[28:31]
    v_mfma_f32_16x16x32_bf16 v[40:43], v[204:207], v[72:75], v[40:43]
    v_mfma_f32_16x16x32_bf16 v[44:47], v[204:207], v[76:79], v[44:47]
    v_mfma_f32_16x16x32_bf16 v[56:59], v[244:247], v[72:75], v[56:59]
    v_mfma_f32_16x16x32_bf16 v[60:63], v[244:247], v[76:79], v[60:63]
    s_cmp_ge_u32 s46, 4
    s_cbranch_scc1 Ld16_59
    s_add_u32 s53, s76, 46080
    buffer_load_dwordx4 v[156:159], v2, s[24:27], s53 offen sc1
    s_add_u32 s53, s76, 47104
    buffer_load_dwordx4 v[196:199], v2, s[24:27], s53 offen sc1
    s_add_u32 s53, s76, 48128
    buffer_load_dwordx4 v[236:239], v2, s[24:27], s53 offen sc1
Ld16_59:
    ds_read2st64_b64 v[72:75], v6 offset0:2 offset1:3
    ds_read2st64_b64 v[76:79], v6 offset0:42 offset1:43
    s_waitcnt lgkmcnt(2)
    v_mfma_f32_16x16x32_bf16 v[24:27], v[168:171], v[64:67], v[24:27]
    v_add_f32 v80, v100, v101
    v_add_f32 v80, v80, v102
    v_mfma_f32_16x16x32_bf16 v[28:31], v[168:171], v[68:71], v[28:31]
    v_add_f32 v80, v80, v103
    v_add_f32 v80, v80, v104
    v_mfma_f32_16x16x32_bf16 v[40:43], v[208:211], v[64:67], v[40:43]
    v_add_f32 v80, v80, v105
    v_add_f32 v80, v80, v106
    v_mfma_f32_16x16x32_bf16 v[44:47], v[208:211], v[68:71], v[44:47]
    v_add_f32 v80, v80, v107
    v_mov_b32 v82, v80
    v_mfma_f32_16x16x32_bf16 v[56:59], v[248:251], v[64:67], v[56:59]
    s_nop 0
    v_permlane32_swap_b32 v80, v82
    v_mov_b32 v81, v80
    v_mfma_f32_16x16x32_bf16 v[60:63], v[248:251], v[68:71], v[60:63]
    v_mov_b32 v83, v82
    v_permlane16_swap_b32 v80, v81
    ds_read_b128 v[64:67], v3 offset:6144
    ds_read_b128 v[68:71], v3 offset:26624
    s_waitcnt lgkmcnt(2)
    v_mfma_f32_16x16x32_bf16 v[24:27], v[172:175], v[72:75], v[24:27]
    v_permlane16_swap_b32 v82, v83
    v_mul_f32 v80, 0x3acccccd, v80
    v_mfma_f32_16x16x32_bf16 v[28:31], v[172:175], v[76:79], v[28:31]
    v_mul_f32 v81, 0x3acccccd, v81
    v_fma_f32 v81, -v80, v80, v81
    v_mfma_f32_16x16x32_bf16 v[40:43], v[212:215], v[72:75], v[40:43]
    v_max_f32 v81, 0, v81
    v_add_f32 v81, 0x3727c5ac, v81
    v_mfma_f32_16x16x32_bf16 v[44:47], v[212:215], v[76:79], v[44:47]
    v_rsq_f32 v81, v81
    s_nop 0
    v_mul_f32 v80, v80, v81
    v_mfma_f32_16x16x32_bf16 v[56:59], v[252:255], v[72:75], v[56:59]
    v_mul_f32 v82, 0x3acccccd, v82
    v_mul_f32 v83, 0x3acccccd, v83
    v_mfma_f32_16x16x32_bf16 v[60:63], v[252:255], v[76:79], v[60:63]
    v_fma_f32 v83, -v82, v82, v83
    v_max_f32 v83, 0, v83
    ds_read_b128 v[72:75], v3 offset:7168
    ds_read_b128 v[76:79], v3 offset:27648
    s_waitcnt lgkmcnt(2)
    v_mfma_f32_16x16x32_bf16 v[16:19], v[160:163], v[64:67], v[16:19]
    v_add_f32 v83, 0x3727c5ac, v83
    v_rsq_f32 v83, v83
    v_mfma_f32_16x16x32_bf16 v[20:23], v[160:163], v[68:71], v[20:23]
    v_mul_f32 v82, v82, v83
    v_lshlrev_b32 v84, 16, v128
    v_mfma_f32_16x16x32_bf16 v[32:35], v[200:203], v[64:67], v[32:35]
    v_fma_f32 v100, -v82, v88, v84
    v_fma_f32 v88, -v80, v88, v84
    v_mfma_f32_16x16x32_bf16 v[36:39], v[200:203], v[68:71], v[36:39]
    v_and_b32 v84, 0xffff0000, v128
    v_fma_f32 v101, -v82, v89, v84
    ds_write_b128 v8, v[24:27] offset:0
    v_mfma_f32_16x16x32_bf16 v[48:51], v[240:243], v[64:67], v[48:51]
    v_fma_f32 v89, -v80, v89, v84
    v_lshlrev_b32 v84, 16, v129
    v_mfma_f32_16x16x32_bf16 v[52:55], v[240:243], v[68:71], v[52:55]
    v_fma_f32 v102, -v82, v90, v84
    v_fma_f32 v90, -v80, v90, v84
    ds_write_b128 v8, v[28:31] offset:1024
    s_cmp_ge_u32 s46, 4
    s_cbranch_scc1 Ld16_60
    s_add_u32 s53, s76, 49152
    buffer_load_dwordx4 v[160:163], v2, s[24:27], s53 offen sc1
    s_add_u32 s53, s76, 50176
    buffer_load_dwordx4 v[200:203], v2, s[24:27], s53 offen sc1
    s_add_u32 s53, s76, 56320
    buffer_load_dwordx4 v[240:243], v2, s[24:27], s53 offen sc1
Ld16_60:
    ds_read2st64_b64 v[64:67], v5 offset0:0 offset1:1
    ds_read2st64_b64 v[68:71], v5 offset0:40 offset1:41
    s_waitcnt lgkmcnt(2)
    v_mfma_f32_16x16x32_bf16 v[16:19], v[164:167], v[72:75], v[16:19]
    v_and_b32 v84, 0xffff0000, v129
    v_fma_f32 v103, -v82, v91, v84
    v_mfma_f32_16x16x32_bf16 v[20:23], v[164:167], v[76:79], v[20:23]
    v_fma_f32 v91, -v80, v91, v84
    v_lshlrev_b32 v84, 16, v130
    ds_write_b128 v8, v[40:43] offset:2048
    v_mfma_f32_16x16x32_bf16 v[32:35], v[204:207], v[72:75], v[32:35]
    v_fma_f32 v104, -v82, v92, v84
    v_fma_f32 v92, -v80, v92, v84
    v_mfma_f32_16x16x32_bf16 v[36:39], v[204:207], v[76:79], v[36:39]
    v_and_b32 v84, 0xffff0000, v130
    v_fma_f32 v105, -v82, v93, v84
    ds_write_b128 v8, v[44:47] offset:3072
    v_mfma_f32_16x16x32_bf16 v[48:51], v[244:247], v[72:75], v[48:51]
    v_fma_f32 v93, -v80, v93, v84
    v_lshlrev_b32 v84, 16, v131
    v_mfma_f32_16x16x32_bf16 v[52:55], v[244:247], v[76:79], v[52:55]
    v_fma_f32 v106, -v82, v94, v84
    v_fma_f32 v94, -v80, v94, v84
    ds_write_b128 v8, v[56:59] offset:4096
    s_cmp_ge_u32 s46, 4
    s_cbranch_scc1 Ld16_61
    s_add_u32 s53, s76, 57344
    buffer_load_dwordx4 v[164:167], v2, s[24:27], s53 offen sc1
    s_add_u32 s53, s76, 58368
    buffer_load_dwordx4 v[204:207], v2, s[24:27], s53 offen sc1
    s_add_u32 s53, s76, 59392
    buffer_load_dwordx4 v[244:247], v2, s[24:27], s53 offen sc1
Ld16_61:
    ds_read2st64_b64 v[72:75], v5 offset0:2 offset1:3
    ds_read2st64_b64 v[76:79], v5 offset0:42 offset1:43
    s_waitcnt lgkmcnt(2)
    v_mfma_f32_16x16x32_bf16 v[16:19], v[168:171], v[64:67], v[16:19]
    v_and_b32 v84, 0xffff0000, v131
    v_fma_f32 v107, -v82, v95, v84
    v_mfma_f32_16x16x32_bf16 v[20:23], v[168:171], v[68:71], v[20:23]
    v_fma_f32 v95, -v80, v95, v84
    v_lshlrev_b32 v84, 16, v132
    ds_write_b128 v8, v[60:63] offset:5120
    v_mfma_f32_16x16x32_bf16 v[32:35], v[208:211], v[64:67], v[32:35]
    v_fma_f32 v108, -v82, v96, v84
    v_fma_f32 v96, -v80, v96, v84
    v_mfma_f32_16x16x32_bf16 v[36:39], v[208:211], v[68:71], v[36:39]
    v_and_b32 v84, 0xffff0000, v132
    v_fma_f32 v109, -v82, v97, v84
    v_mfma_f32_16x16x32_bf16 v[48:51], v[248:251], v[64:67], v[48:51]
    v_fma_f32 v97, -v80, v97, v84
    v_lshlrev_b32 v84, 16, v133
    v_mfma_f32_16x16x32_bf16 v[52:55], v[248:251], v[68:71], v[52:55]
    v_fma_f32 v110, -v82, v98, v84
    v_fma_f32 v98, -v80, v98, v84
    s_cmp_ge_u32 s46, 4
    s_cbranch_scc1 Ld16_62
    s_add_u32 s53, s76, 60416
    buffer_load_dwordx4 v[168:171], v2, s[24:27], s53 offen sc1
    s_add_u32 s53, s76, 66560
    buffer_load_dwordx4 v[208:211], v2, s[24:27], s53 offen sc1
    s_add_u32 s53, s76, 67584
    buffer_load_dwordx4 v[248:251], v2, s[24:27], s53 offen sc1
Ld16_62:
    s_waitcnt lgkmcnt(0)
    v_mfma_f32_16x16x32_bf16 v[16:19], v[172:175], v[72:75], v[16:19]
    v_and_b32 v84, 0xffff0000, v133
    v_fma_f32 v111, -v82, v99, v84
    v_mfma_f32_16x16x32_bf16 v[20:23], v[172:175], v[76:79], v[20:23]
    v_fma_f32 v99, -v80, v99, v84
    v_mfma_f32_16x16x32_bf16 v[32:35], v[212:215], v[72:75], v[32:35]
    v_mfma_f32_16x16x32_bf16 v[36:39], v[212:215], v[76:79], v[36:39]
    v_mfma_f32_16x16x32_bf16 v[48:51], v[252:255], v[72:75], v[48:51]
    v_mfma_f32_16x16x32_bf16 v[52:55], v[252:255], v[76:79], v[52:55]
    s_cmp_ge_u32 s46, 4
    s_cbranch_scc1 Ld16_63
    s_add_u32 s53, s76, 68608
    buffer_load_dwordx4 v[172:175], v2, s[24:27], s53 offen sc1
    s_add_u32 s53, s76, 69632
    buffer_load_dwordx4 v[212:215], v2, s[24:27], s53 offen sc1
    s_add_u32 s53, s76, 70656
    buffer_load_dwordx4 v[252:255], v2, s[24:27], s53 offen sc1
Ld16_63:
    s_barrier
    ds_read_b128 v[24:27], v9 offset:0
    ds_read_b128 v[28:31], v9 offset:1024
    ds_read_b128 v[40:43], v9 offset:2048
    ds_read_b128 v[44:47], v9 offset:3072
    ds_read_b128 v[56:59], v9 offset:4096
    ds_read_b128 v[60:63], v9 offset:5120
    s_waitcnt lgkmcnt(5)
    v_pk_add_f32 v[16:17], v[16:17], v[24:25]
    v_pk_fma_f32 v[16:17], v[16:17], v[80:81], v[88:89] op_sel:[0,1,0] op_sel_hi:[1,1,1]
    v_max_f32 v16, 0, v16
    v_max_f32 v17, 0, v17
    v_pk_mul_f32 v[16:17], v[16:17], v[16:17]
    v_pk_add_f32 v[18:19], v[18:19], v[26:27]
    v_pk_fma_f32 v[18:19], v[18:19], v[80:81], v[90:91] op_sel:[0,1,0] op_sel_hi:[1,1,1]
    v_max_f32 v18, 0, v18
    v_max_f32 v19, 0, v19
    v_pk_mul_f32 v[18:19], v[18:19], v[18:19]
    v_cvt_pk_bf16_f32 v64, v16, v17
    v_cvt_pk_bf16_f32 v65, v18, v19
    s_waitcnt lgkmcnt(4)
    v_pk_add_f32 v[20:21], v[20:21], v[28:29]
    v_pk_fma_f32 v[20:21], v[20:21], v[82:83], v[100:101] op_sel:[0,1,0] op_sel_hi:[1,1,1]
    v_max_f32 v20, 0, v20
    v_max_f32 v21, 0, v21
    v_pk_mul_f32 v[20:21], v[20:21], v[20:21]
    v_pk_add_f32 v[22:23], v[22:23], v[30:31]
    v_pk_fma_f32 v[22:23], v[22:23], v[82:83], v[102:103] op_sel:[0,1,0] op_sel_hi:[1,1,1]
    v_max_f32 v22, 0, v22
    v_max_f32 v23, 0, v23
    v_pk_mul_f32 v[22:23], v[22:23], v[22:23]
    v_cvt_pk_bf16_f32 v66, v20, v21
    v_cvt_pk_bf16_f32 v67, v22, v23
    s_nop 0
    v_permlane16_swap_b32 v64, v66
    v_permlane16_swap_b32 v65, v67
    buffer_store_dwordx4 v[64:67], v14, s[24:27], s59 offen offset:0 sc1
    s_waitcnt lgkmcnt(3)
    v_pk_add_f32 v[32:33], v[32:33], v[40:41]
    v_pk_fma_f32 v[32:33], v[32:33], v[80:81], v[92:93] op_sel:[0,1,0] op_sel_hi:[1,1,1]
    v_max_f32 v32, 0, v32
    v_max_f32 v33, 0, v33
    v_pk_mul_f32 v[32:33], v[32:33], v[32:33]
    v_pk_add_f32 v[34:35], v[34:35], v[42:43]
    v_pk_fma_f32 v[34:35], v[34:35], v[80:81], v[94:95] op_sel:[0,1,0] op_sel_hi:[1,1,1]
    v_max_f32 v34, 0, v34
    v_max_f32 v35, 0, v35
    v_pk_mul_f32 v[34:35], v[34:35], v[34:35]
    v_cvt_pk_bf16_f32 v68, v32, v33
    v_cvt_pk_bf16_f32 v69, v34, v35
    s_waitcnt lgkmcnt(2)
    v_pk_add_f32 v[36:37], v[36:37], v[44:45]
    v_pk_fma_f32 v[36:37], v[36:37], v[82:83], v[104:105] op_sel:[0,1,0] op_sel_hi:[1,1,1]
    v_max_f32 v36, 0, v36
    v_max_f32 v37, 0, v37
    v_pk_mul_f32 v[36:37], v[36:37], v[36:37]
    v_pk_add_f32 v[38:39], v[38:39], v[46:47]
    v_pk_fma_f32 v[38:39], v[38:39], v[82:83], v[106:107] op_sel:[0,1,0] op_sel_hi:[1,1,1]
    v_max_f32 v38, 0, v38
    v_max_f32 v39, 0, v39
    v_pk_mul_f32 v[38:39], v[38:39], v[38:39]
    v_cvt_pk_bf16_f32 v70, v36, v37
    v_cvt_pk_bf16_f32 v71, v38, v39
    s_nop 0
    v_permlane16_swap_b32 v68, v70
    v_permlane16_swap_b32 v69, v71
    buffer_store_dwordx4 v[68:71], v14, s[24:27], s59 offen offset:512 sc1
    s_waitcnt lgkmcnt(1)
    v_pk_add_f32 v[48:49], v[48:49], v[56:57]
    v_pk_fma_f32 v[48:49], v[48:49], v[80:81], v[96:97] op_sel:[0,1,0] op_sel_hi:[1,1,1]
    v_max_f32 v48, 0, v48
    v_max_f32 v49, 0, v49
    v_pk_mul_f32 v[48:49], v[48:49], v[48:49]
    v_pk_add_f32 v[50:51], v[50:51], v[58:59]
    v_pk_fma_f32 v[50:51], v[50:51], v[80:81], v[98:99] op_sel:[0,1,0] op_sel_hi:[1,1,1]
    v_max_f32 v50, 0, v50
    v_max_f32 v51, 0, v51
    v_pk_mul_f32 v[50:51], v[50:51], v[50:51]
    v_cvt_pk_bf16_f32 v72, v48, v49
    v_cvt_pk_bf16_f32 v73, v50, v51
    s_waitcnt lgkmcnt(0)
    v_pk_add_f32 v[52:53], v[52:53], v[60:61]
    v_pk_fma_f32 v[52:53], v[52:53], v[82:83], v[108:109] op_sel:[0,1,0] op_sel_hi:[1,1,1]
    v_max_f32 v52, 0, v52
    v_max_f32 v53, 0, v53
    v_pk_mul_f32 v[52:53], v[52:53], v[52:53]
    v_pk_add_f32 v[54:55], v[54:55], v[62:63]
    v_pk_fma_f32 v[54:55], v[54:55], v[82:83], v[110:111] op_sel:[0,1,0] op_sel_hi:[1,1,1]
    v_max_f32 v54, 0, v54
    v_max_f32 v55, 0, v55
    v_pk_mul_f32 v[54:55], v[54:55], v[54:55]
    v_cvt_pk_bf16_f32 v74, v52, v53
    v_cvt_pk_bf16_f32 v75, v54, v55
    s_nop 0
    v_permlane16_swap_b32 v72, v74
    v_permlane16_swap_b32 v73, v75
    buffer_store_dwordx4 v[72:75], v14, s[24:27], s59 offen offset:1024 sc1
    s_lshl_b32 s52, s96, 8
    s_lshl_b32 s53, s51, 5
    s_add_u32 s52, s52, s53
    s_add_u32 s52, s52, 21135360
    v_mov_b32 v10, s48
    v_mov_b32 v11, s49
    v_lshlrev_b32 v12, 3, v1
    s_cmp_lg_u32 s46, 3
    s_waitcnt vmcnt(0)
    s_barrier
    s_cbranch_scc1 Lff_64
    s_mov_b64 exec, 0xf
    buffer_store_dwordx2 v[10:11], v12, s[24:27], s52 offen sc1
    s_mov_b64 exec, -1
Lff_64:
    s_cmp_lt_u32 s46, 4
    s_cbranch_scc1 L_E_help
    s_bfe_u32 s55, s46, 0x10001
    s_and_b32 s56, s46, 1
    s_mul_i32 s52, s46, 5120
    v_add_u32 v3, s52, v2
    ds_write_b128 v3, v[136:139] offset:51200
    ds_write_b128 v3, v[176:179] offset:52224
    ds_write_b128 v3, v[216:219] offset:53248
    ds_write_b128 v3, v[140:143] offset:54272
    ds_write_b128 v3, v[180:183] offset:55296
    ds_write_b128 v3, v[220:223] offset:0
    ds_write_b128 v3, v[144:147] offset:1024
    ds_write_b128 v3, v[184:187] offset:2048
    ds_write_b128 v3, v[224:227] offset:3072
    ds_write_b128 v3, v[148:151] offset:4096
    s_cmp_ge_u32 s46, 2
    s_cbranch_scc1 Le15_65
    ds_write_b128 v3, v[188:191] offset:40960
    ds_write_b128 v3, v[228:231] offset:41984
    ds_write_b128 v3, v[152:155] offset:43008
    ds_write_b128 v3, v[192:195] offset:44032
    ds_write_b128 v3, v[232:235] offset:45056
Le15_65:
    s_mul_i32 s52, s55, 5120
    v_add_u32 v5, s52, v2
    s_lshl_b32 s52, s55, 11
    v_add_u32 v3, s52, v5
    s_xor_b32 s52, s52, 2048
    v_add_u32 v4, s52, v5
    v_add_u32 v6, 61440, v3
    v_add_u32 v7, 61440, v4
    v_add_u32 v8, 61440, v5
    v_add_u32 v9, 122880, v3
    v_add_u32 v14, 122880, v4
    v_add_u32 v0, 122880, v5
    s_lshl_b32 s54, s56, 1
    s_add_u32 s54, s54, s95
    s_mul_i32 s59, s54, 49152
    s_mul_i32 s53, s55, 24576
    s_add_u32 s59, s59, s53
    s_add_u32 s59, s59, 14680064
    v_lshlrev_b32 v68, 16, v86
    v_and_b32 v69, 0xffff0000, v86
    v_lshlrev_b32 v70, 16, v87
    v_and_b32 v71, 0xffff0000, v87
    v_lshlrev_b32 v16, 16, v116
    v_and_b32 v17, 0xffff0000, v116
    v_lshlrev_b32 v18, 16, v117
    v_and_b32 v19, 0xffff0000, v117
    v_pk_add_f32 v[16:17], v[16:17], v[68:69]
    v_pk_add_f32 v[18:19], v[18:19], v[70:71]
    v_lshlrev_b32 v20, 16, v120
    v_and_b32 v21, 0xffff0000, v120
    v_lshlrev_b32 v22, 16, v121
    v_and_b32 v23, 0xffff0000, v121
    v_pk_add_f32 v[20:21], v[20:21], v[68:69]
    v_pk_add_f32 v[22:23], v[22:23], v[70:71]
    v_lshlrev_b32 v68, 16, v112
    v_and_b32 v69, 0xffff0000, v112
    v_lshlrev_b32 v70, 16, v113
    v_and_b32 v71, 0xffff0000, v113
    v_lshlrev_b32 v24, 16, v118
    v_and_b32 v25, 0xffff0000, v118
    v_lshlrev_b32 v26, 16, v119
    v_and_b32 v27, 0xffff0000, v119
    v_pk_add_f32 v[24:25], v[24:25], v[68:69]
    v_pk_add_f32 v[26:27], v[26:27], v[70:71]
    v_lshlrev_b32 v28, 16, v122
    v_and_b32 v29, 0xffff0000, v122
    v_lshlrev_b32 v30, 16, v123
    v_and_b32 v31, 0xffff0000, v123
    v_pk_add_f32 v[28:29], v[28:29], v[68:69]
    v_pk_add_f32 v[30:31], v[30:31], v[70:71]
    v_lshlrev_b32 v68, 16, v114
    v_and_b32 v69, 0xffff0000, v114
    v_lshlrev_b32 v70, 16, v115
    v_and_b32 v71, 0xffff0000, v115
    v_lshlrev_b32 v48, 16, v124
    v_and_b32 v49, 0xffff0000, v124
    v_lshlrev_b32 v50, 16, v125
    v_and_b32 v51, 0xffff0000, v125
    v_pk_add_f32 v[48:49], v[48:49], v[68:69]
    v_pk_add_f32 v[50:51], v[50:51], v[70:71]
    v_lshlrev_b32 v52, 16, v126
    v_and_b32 v53, 0xffff0000, v126
    v_lshlrev_b32 v54, 16, v127
    v_and_b32 v55, 0xffff0000, v127
    v_pk_add_f32 v[52:53], v[52:53], v[68:69]
    v_pk_add_f32 v[54:55], v[54:55], v[70:71]
    v_mov_b32 v32, 0
    v_mov_b32 v33, 0
    v_mov_b32 v34, 0
    v_mov_b32 v35, 0
    v_mov_b32 v36, 0
    v_mov_b32 v37, 0
    v_mov_b32 v38, 0
    v_mov_b32 v39, 0
    v_mov_b32 v40, 0
    v_mov_b32 v41, 0
    v_mov_b32 v42, 0
    v_mov_b32 v43, 0
    v_mov_b32 v44, 0
    v_mov_b32 v45, 0
    v_mov_b32 v46, 0
    v_mov_b32 v47, 0
    s_cmp_eq_u32 s55, 0
    s_cselect_b64 vcc, -1, 0
    v_cndmask_b32 v48, 0, v48, vcc
    v_cndmask_b32 v49, 0, v49, vcc
    v_cndmask_b32 v50, 0, v50, vcc
    v_cndmask_b32 v51, 0, v51, vcc
    v_cndmask_b32 v52, 0, v52, vcc
    v_cndmask_b32 v53, 0, v53, vcc
    v_cndmask_b32 v54, 0, v54, vcc
    v_cndmask_b32 v55, 0, v55, vcc
    ds_read_b128 v[56:59], v9 offset:0
    ds_read_b128 v[60:63], v9 offset:1024
    ds_read_b128 v[64:67], v14 offset:0
    ds_read_b128 v[68:71], v14 offset:1024
    ds_read_b128 v[72:75], v0 offset:4096
    v_and_b32 v10, 7, v1
    v_lshlrev_b32 v10, 5, v10
    s_lshl_b32 s52, s96, 8
    s_add_u32 s52, s52, 21135360
    s_waitcnt lgkmcnt(0)
    s_mov_b32 s94, 0
Lpoll_66:
    buffer_load_dwordx2 v[12:13], v10, s[24:27], s52 offen sc1
    s_add_u32 s94, s94, 1
    s_waitcnt vmcnt(0)
    v_cmp_ne_u64 vcc, s[48:49], v[12:13]
    s_cbranch_vccz Lpolle_67
    s_cmp_le_u32 s94, 0x40000
    s_cbranch_scc1 Lpoll_66
Lpolle_67:
    s_add_u32 s57, s59, 0
    buffer_load_dwordx4 v[96:99], v2, s[24:27], s57 offen offset:0 sc1
    s_add_u32 s57, s59, 49152
    buffer_load_dwordx4 v[100:103], v2, s[24:27], s57 offen offset:0 sc1
    s_add_u32 s57, s59, 0
    buffer_load_dwordx4 v[104:107], v2, s[24:27], s57 offen offset:1024 sc1
    s_add_u32 s57, s59, 49152
    buffer_load_dwordx4 v[108:111], v2, s[24:27], s57 offen offset:1024 sc1
    s_add_u32 s57, s59, 0
    buffer_load_dwordx4 v[112:115], v2, s[24:27], s57 offen offset:2048 sc1
    s_add_u32 s57, s59, 49152
    buffer_load_dwordx4 v[116:119], v2, s[24:27], s57 offen offset:2048 sc1
    s_add_u32 s57, s59, 0
    buffer_load_dwordx4 v[120:123], v2, s[24:27], s57 offen offset:3072 sc1
    s_add_u32 s57, s59, 49152
    buffer_load_dwordx4 v[124:127], v2, s[24:27], s57 offen offset:3072 sc1
    s_add_u32 s57, s59, 4096
    buffer_load_dwordx4 v[128:131], v2, s[24:27], s57 offen offset:0 sc1
    s_add_u32 s57, s59, 53248
    buffer_load_dwordx4 v[132:135], v2, s[24:27], s57 offen offset:0 sc1
    s_add_u32 s57, s59, 4096
    buffer_load_dwordx4 v[136:139], v2, s[24:27], s57 offen offset:1024 sc1
    s_add_u32 s57, s59, 53248
    buffer_load_dwordx4 v[140:143], v2, s[24:27], s57 offen offset:1024 sc1
    s_and_b32 s52, s46, 3
    s_lshl_b32 s52, s52, 12
    v_add_u32 v10, s52, v2
    s_xor_b32 s52, s52, 8192
    v_add_u32 v11, s52, v2
    s_lshl_b32 s52, s56, 11
    s_add_u32 s52, s52, 16384
    v_add_u32 v13, s52, v2
    s_xor_b32 s53, s55, 1
    s_lshl_b32 s53, s53, 12
    v_add_u32 v12, s53, v13
    s_waitcnt vmcnt(10) lgkmcnt(0)
    ds_read_b128 v[76:79], v9 offset:10240
    v_mfma_f32_16x16x32_bf16 v[16:19], v[56:59], v[96:99], v[16:19]
    ds_read_b128 v[80:83], v9 offset:11264
    v_mfma_f32_16x16x32_bf16 v[20:23], v[56:59], v[100:103], v[20:23]
    ds_read_b128 v[84:87], v14 offset:10240
    v_mfma_f32_16x16x32_bf16 v[24:27], v[60:63], v[96:99], v[24:27]
    ds_read_b128 v[88:91], v14 offset:11264
    v_mfma_f32_16x16x32_bf16 v[28:31], v[60:63], v[100:103], v[28:31]
    ds_read_b128 v[92:95], v0 offset:14336
    v_mfma_f32_16x16x32_bf16 v[32:35], v[64:67], v[96:99], v[32:35]
    v_mfma_f32_16x16x32_bf16 v[36:39], v[64:67], v[100:103], v[36:39]
    s_add_u32 s57, s59, 4096
    buffer_load_dwordx4 v[144:147], v2, s[24:27], s57 offen offset:2048 sc1
    s_add_u32 s57, s59, 53248
    buffer_load_dwordx4 v[148:151], v2, s[24:27], s57 offen offset:2048 sc1
    v_mfma_f32_16x16x32_bf16 v[40:43], v[68:71], v[96:99], v[40:43]
    v_mfma_f32_16x16x32_bf16 v[44:47], v[68:71], v[100:103], v[44:47]
    v_mfma_f32_16x16x32_bf16 v[48:51], v[72:75], v[96:99], v[48:51]
    v_mfma_f32_16x16x32_bf16 v[52:55], v[72:75], v[100:103], v[52:55]
    s_waitcnt vmcnt(10) lgkmcnt(0)
    ds_read_b128 v[56:59], v9 offset:20480
    v_mfma_f32_16x16x32_bf16 v[16:19], v[76:79], v[104:107], v[16:19]
    ds_read_b128 v[60:63], v9 offset:21504
    v_mfma_f32_16x16x32_bf16 v[20:23], v[76:79], v[108:111], v[20:23]
    ds_read_b128 v[64:67], v14 offset:20480
    v_mfma_f32_16x16x32_bf16 v[24:27], v[80:83], v[104:107], v[24:27]
    ds_read_b128 v[68:71], v14 offset:21504
    v_mfma_f32_16x16x32_bf16 v[28:31], v[80:83], v[108:111], v[28:31]
    ds_read_b128 v[72:75], v0 offset:24576
    v_mfma_f32_16x16x32_bf16 v[32:35], v[84:87], v[104:107], v[32:35]
    v_mfma_f32_16x16x32_bf16 v[36:39], v[84:87], v[108:111], v[36:39]
    s_add_u32 s57, s59, 4096
    buffer_load_dwordx4 v[152:155], v2, s[24:27], s57 offen offset:3072 sc1
    s_add_u32 s57, s59, 53248
    buffer_load_dwordx4 v[156:159], v2, s[24:27], s57 offen offset:3072 sc1
    v_mfma_f32_16x16x32_bf16 v[40:43], v[88:91], v[104:107], v[40:43]
    v_mfma_f32_16x16x32_bf16 v[44:47], v[88:91], v[108:111], v[44:47]
    v_mfma_f32_16x16x32_bf16 v[48:51], v[92:95], v[104:107], v[48:51]
    v_mfma_f32_16x16x32_bf16 v[52:55], v[92:95], v[108:111], v[52:55]
    s_waitcnt vmcnt(10) lgkmcnt(0)
    ds_read_b128 v[76:79], v9 offset:30720
    v_mfma_f32_16x16x32_bf16 v[16:19], v[56:59], v[112:115], v[16:19]
    ds_read_b128 v[80:83], v9 offset:31744
    v_mfma_f32_16x16x32_bf16 v[20:23], v[56:59], v[116:119], v[20:23]
    ds_read_b128 v[84:87], v14 offset:30720
    v_mfma_f32_16x16x32_bf16 v[24:27], v[60:63], v[112:115], v[24:27]
    ds_read_b128 v[88:91], v14 offset:31744
    v_mfma_f32_16x16x32_bf16 v[28:31], v[60:63], v[116:119], v[28:31]
    ds_read_b128 v[92:95], v0 offset:34816
    v_mfma_f32_16x16x32_bf16 v[32:35], v[64:67], v[112:115], v[32:35]
    v_mfma_f32_16x16x32_bf16 v[36:39], v[64:67], v[116:119], v[36:39]
    s_add_u32 s57, s59, 8192
    buffer_load_dwordx4 v[160:163], v2, s[24:27], s57 offen offset:0 sc1
    s_add_u32 s57, s59, 57344
    buffer_load_dwordx4 v[164:167], v2, s[24:27], s57 offen offset:0 sc1
    v_mfma_f32_16x16x32_bf16 v[40:43], v[68:71], v[112:115], v[40:43]
    v_mfma_f32_16x16x32_bf16 v[44:47], v[68:71], v[116:119], v[44:47]
    v_mfma_f32_16x16x32_bf16 v[48:51], v[72:75], v[112:115], v[48:51]
    v_mfma_f32_16x16x32_bf16 v[52:55], v[72:75], v[116:119], v[52:55]
    s_waitcnt vmcnt(10) lgkmcnt(0)
    ds_read_b128 v[56:59], v6 offset:30720
    v_mfma_f32_16x16x32_bf16 v[16:19], v[76:79], v[120:123], v[16:19]
    ds_read_b128 v[60:63], v6 offset:31744
    v_mfma_f32_16x16x32_bf16 v[20:23], v[76:79], v[124:127], v[20:23]
    ds_read_b128 v[64:67], v7 offset:30720
    v_mfma_f32_16x16x32_bf16 v[24:27], v[80:83], v[120:123], v[24:27]
    ds_read_b128 v[68:71], v7 offset:31744
    v_mfma_f32_16x16x32_bf16 v[28:31], v[80:83], v[124:127], v[28:31]
    ds_read_b128 v[72:75], v8 offset:34816
    v_mfma_f32_16x16x32_bf16 v[32:35], v[84:87], v[120:123], v[32:35]
    v_mfma_f32_16x16x32_bf16 v[36:39], v[84:87], v[124:127], v[36:39]
    s_add_u32 s57, s59, 8192
    buffer_load_dwordx4 v[168:171], v2, s[24:27], s57 offen offset:1024 sc1
    s_add_u32 s57, s59, 57344
    buffer_load_dwordx4 v[172:175], v2, s[24:27], s57 offen offset:1024 sc1
    v_mfma_f32_16x16x32_bf16 v[40:43], v[88:91], v[120:123], v[40:43]
    v_mfma_f32_16x16x32_bf16 v[44:47], v[88:91], v[124:127], v[44:47]
    v_mfma_f32_16x16x32_bf16 v[48:51], v[92:95], v[120:123], v[48:51]
    v_mfma_f32_16x16x32_bf16 v[52:55], v[92:95], v[124:127], v[52:55]
    s_barrier
    s_waitcnt vmcnt(10) lgkmcnt(0)
    ds_read_b128 v[76:79], v6 offset:40960
    v_mfma_f32_16x16x32_bf16 v[16:19], v[56:59], v[128:131], v[16:19]
    ds_read_b128 v[80:83], v6 offset:41984
    v_mfma_f32_16x16x32_bf16 v[20:23], v[56:59], v[132:135], v[20:23]
    ds_read_b128 v[84:87], v7 offset:40960
    v_mfma_f32_16x16x32_bf16 v[24:27], v[60:63], v[128:131], v[24:27]
    ds_read_b128 v[88:91], v7 offset:41984
    v_mfma_f32_16x16x32_bf16 v[28:31], v[60:63], v[132:135], v[28:31]
    ds_read_b128 v[92:95], v8 offset:45056
    v_mfma_f32_16x16x32_bf16 v[32:35], v[64:67], v[128:131], v[32:35]
    v_mfma_f32_16x16x32_bf16 v[36:39], v[64:67], v[132:135], v[36:39]
    s_add_u32 s57, s59, 8192
    buffer_load_dwordx4 v[176:179], v2, s[24:27], s57 offen offset:2048 sc1
    s_add_u32 s57, s59, 57344
    buffer_load_dwordx4 v[180:183], v2, s[24:27], s57 offen offset:2048 sc1
    v_mfma_f32_16x16x32_bf16 v[40:43], v[68:71], v[128:131], v[40:43]
    v_mfma_f32_16x16x32_bf16 v[44:47], v[68:71], v[132:135], v[44:47]
    v_mfma_f32_16x16x32_bf16 v[48:51], v[72:75], v[128:131], v[48:51]
    v_mfma_f32_16x16x32_bf16 v[52:55], v[72:75], v[132:135], v[52:55]
    s_waitcnt vmcnt(10) lgkmcnt(0)
    ds_read_b128 v[56:59], v6 offset:51200
    v_mfma_f32_16x16x32_bf16 v[16:19], v[76:79], v[136:139], v[16:19]
    ds_read_b128 v[60:63], v6 offset:52224
    v_mfma_f32_16x16x32_bf16 v[20:23], v[76:79], v[140:143], v[20:23]
    ds_read_b128 v[64:67], v7 offset:51200
    v_mfma_f32_16x16x32_bf16 v[24:27], v[80:83], v[136:139], v[24:27]
    ds_read_b128 v[68:71], v7 offset:52224
    v_mfma_f32_16x16x32_bf16 v[28:31], v[80:83], v[140:143], v[28:31]
    ds_read_b128 v[72:75], v8 offset:55296
    v_mfma_f32_16x16x32_bf16 v[32:35], v[84:87], v[136:139], v[32:35]
    v_mfma_f32_16x16x32_bf16 v[36:39], v[84:87], v[140:143], v[36:39]
    s_add_u32 s57, s59, 8192
    buffer_load_dwordx4 v[184:187], v2, s[24:27], s57 offen offset:3072 sc1
    s_add_u32 s57, s59, 57344
    buffer_load_dwordx4 v[188:191], v2, s[24:27], s57 offen offset:3072 sc1
    v_mfma_f32_16x16x32_bf16 v[40:43], v[88:91], v[136:139], v[40:43]
    v_mfma_f32_16x16x32_bf16 v[44:47], v[88:91], v[140:143], v[44:47]
    v_mfma_f32_16x16x32_bf16 v[48:51], v[92:95], v[136:139], v[48:51]
    v_mfma_f32_16x16x32_bf16 v[52:55], v[92:95], v[140:143], v[52:55]
    s_waitcnt vmcnt(10) lgkmcnt(0)
    ds_read_b128 v[76:79], v3 offset:51200
    v_mfma_f32_16x16x32_bf16 v[16:19], v[56:59], v[144:147], v[16:19]
    ds_read_b128 v[80:83], v3 offset:52224
    v_mfma_f32_16x16x32_bf16 v[20:23], v[56:59], v[148:151], v[20:23]
    ds_read_b128 v[84:87], v4 offset:51200
    v_mfma_f32_16x16x32_bf16 v[24:27], v[60:63], v[144:147], v[24:27]
    ds_read_b128 v[88:91], v4 offset:52224
    v_mfma_f32_16x16x32_bf16 v[28:31], v[60:63], v[148:151], v[28:31]
    ds_read_b128 v[92:95], v5 offset:55296
    v_mfma_f32_16x16x32_bf16 v[32:35], v[64:67], v[144:147], v[32:35]
    v_mfma_f32_16x16x32_bf16 v[36:39], v[64:67], v[148:151], v[36:39]
    s_add_u32 s57, s59, 12288
    buffer_load_dwordx4 v[192:195], v2, s[24:27], s57 offen offset:0 sc1
    s_add_u32 s57, s59, 61440
    buffer_load_dwordx4 v[196:199], v2, s[24:27], s57 offen offset:0 sc1
    v_mfma_f32_16x16x32_bf16 v[40:43], v[68:71], v[144:147], v[40:43]
    v_mfma_f32_16x16x32_bf16 v[44:47], v[68:71], v[148:151], v[44:47]
    v_mfma_f32_16x16x32_bf16 v[48:51], v[72:75], v[144:147], v[48:51]
    v_mfma_f32_16x16x32_bf16 v[52:55], v[72:75], v[148:151], v[52:55]
    s_waitcnt vmcnt(10) lgkmcnt(0)
    ds_read_b128 v[56:59], v6 offset:0
    v_mfma_f32_16x16x32_bf16 v[16:19], v[76:79], v[152:155], v[16:19]
    ds_read_b128 v[60:63], v6 offset:1024
    v_mfma_f32_16x16x32_bf16 v[20:23], v[76:79], v[156:159], v[20:23]
    ds_read_b128 v[64:67], v7 offset:0
    v_mfma_f32_16x16x32_bf16 v[24:27], v[80:83], v[152:155], v[24:27]
    ds_read_b128 v[68:71], v7 offset:1024
    v_mfma_f32_16x16x32_bf16 v[28:31], v[80:83], v[156:159], v[28:31]
    ds_read_b128 v[72:75], v8 offset:4096
    v_mfma_f32_16x16x32_bf16 v[32:35], v[84:87], v[152:155], v[32:35]
    v_mfma_f32_16x16x32_bf16 v[36:39], v[84:87], v[156:159], v[36:39]
    s_add_u32 s57, s59, 12288
    buffer_load_dwordx4 v[200:203], v2, s[24:27], s57 offen offset:1024 sc1
    s_add_u32 s57, s59, 61440
    buffer_load_dwordx4 v[204:207], v2, s[24:27], s57 offen offset:1024 sc1
    v_mfma_f32_16x16x32_bf16 v[40:43], v[88:91], v[152:155], v[40:43]
    v_mfma_f32_16x16x32_bf16 v[44:47], v[88:91], v[156:159], v[44:47]
    v_mfma_f32_16x16x32_bf16 v[48:51], v[92:95], v[152:155], v[48:51]
    v_mfma_f32_16x16x32_bf16 v[52:55], v[92:95], v[156:159], v[52:55]
    s_barrier
    s_waitcnt vmcnt(10) lgkmcnt(0)
    ds_read_b128 v[76:79], v6 offset:10240
    v_mfma_f32_16x16x32_bf16 v[16:19], v[56:59], v[160:163], v[16:19]
    ds_read_b128 v[80:83], v6 offset:11264
    v_mfma_f32_16x16x32_bf16 v[20:23], v[56:59], v[164:167], v[20:23]
    ds_read_b128 v[84:87], v7 offset:10240
    v_mfma_f32_16x16x32_bf16 v[24:27], v[60:63], v[160:163], v[24:27]
    ds_read_b128 v[88:91], v7 offset:11264
    v_mfma_f32_16x16x32_bf16 v[28:31], v[60:63], v[164:167], v[28:31]
    ds_read_b128 v[92:95], v8 offset:14336
    v_mfma_f32_16x16x32_bf16 v[32:35], v[64:67], v[160:163], v[32:35]
    v_mfma_f32_16x16x32_bf16 v[36:39], v[64:67], v[164:167], v[36:39]
    s_add_u32 s57, s59, 12288
    buffer_load_dwordx4 v[208:211], v2, s[24:27], s57 offen offset:2048 sc1
    s_add_u32 s57, s59, 61440
    buffer_load_dwordx4 v[212:215], v2, s[24:27], s57 offen offset:2048 sc1
    v_mfma_f32_16x16x32_bf16 v[40:43], v[68:71], v[160:163], v[40:43]
    v_mfma_f32_16x16x32_bf16 v[44:47], v[68:71], v[164:167], v[44:47]
    v_mfma_f32_16x16x32_bf16 v[48:51], v[72:75], v[160:163], v[48:51]
    v_mfma_f32_16x16x32_bf16 v[52:55], v[72:75], v[164:167], v[52:55]
    s_waitcnt vmcnt(10) lgkmcnt(0)
    ds_read_b128 v[56:59], v6 offset:20480
    v_mfma_f32_16x16x32_bf16 v[16:19], v[76:79], v[168:171], v[16:19]
    ds_read_b128 v[60:63], v6 offset:21504
    v_mfma_f32_16x16x32_bf16 v[20:23], v[76:79], v[172:175], v[20:23]
    ds_read_b128 v[64:67], v7 offset:20480
    v_mfma_f32_16x16x32_bf16 v[24:27], v[80:83], v[168:171], v[24:27]
    ds_read_b128 v[68:71], v7 offset:21504
    v_mfma_f32_16x16x32_bf16 v[28:31], v[80:83], v[172:175], v[28:31]
    ds_read_b128 v[72:75], v8 offset:24576
    v_mfma_f32_16x16x32_bf16 v[32:35], v[84:87], v[168:171], v[32:35]
    v_mfma_f32_16x16x32_bf16 v[36:39], v[84:87], v[172:175], v[36:39]
    s_add_u32 s57, s59, 12288
    buffer_load_dwordx4 v[216:219], v2, s[24:27], s57 offen offset:3072 sc1
    s_add_u32 s57, s59, 61440
    buffer_load_dwordx4 v[220:223], v2, s[24:27], s57 offen offset:3072 sc1
    v_mfma_f32_16x16x32_bf16 v[40:43], v[88:91], v[168:171], v[40:43]
    v_mfma_f32_16x16x32_bf16 v[44:47], v[88:91], v[172:175], v[44:47]
    v_mfma_f32_16x16x32_bf16 v[48:51], v[92:95], v[168:171], v[48:51]
    v_mfma_f32_16x16x32_bf16 v[52:55], v[92:95], v[172:175], v[52:55]
    s_waitcnt vmcnt(10) lgkmcnt(0)
    ds_read_b128 v[76:79], v3 offset:0
    v_mfma_f32_16x16x32_bf16 v[16:19], v[56:59], v[176:179], v[16:19]
    ds_read_b128 v[80:83], v3 offset:1024
    v_mfma_f32_16x16x32_bf16 v[20:23], v[56:59], v[180:183], v[20:23]
    ds_read_b128 v[84:87], v4 offset:0
    v_mfma_f32_16x16x32_bf16 v[24:27], v[60:63], v[176:179], v[24:27]
    ds_read_b128 v[88:91], v4 offset:1024
    v_mfma_f32_16x16x32_bf16 v[28:31], v[60:63], v[180:183], v[28:31]
    ds_read_b128 v[92:95], v5 offset:4096
    v_mfma_f32_16x16x32_bf16 v[32:35], v[64:67], v[176:179], v[32:35]
    v_mfma_f32_16x16x32_bf16 v[36:39], v[64:67], v[180:183], v[36:39]
    s_add_u32 s57, s59, 16384
    buffer_load_dwordx4 v[224:227], v2, s[24:27], s57 offen offset:0 sc1
    s_add_u32 s57, s59, 65536
    buffer_load_dwordx4 v[228:231], v2, s[24:27], s57 offen offset:0 sc1
    v_mfma_f32_16x16x32_bf16 v[40:43], v[68:71], v[176:179], v[40:43]
    v_mfma_f32_16x16x32_bf16 v[44:47], v[68:71], v[180:183], v[44:47]
    v_mfma_f32_16x16x32_bf16 v[48:51], v[72:75], v[176:179], v[48:51]
    v_mfma_f32_16x16x32_bf16 v[52:55], v[72:75], v[180:183], v[52:55]
    s_waitcnt vmcnt(10) lgkmcnt(0)
    ds_read_b128 v[56:59], v3 offset:10240
    v_mfma_f32_16x16x32_bf16 v[16:19], v[76:79], v[184:187], v[16:19]
    ds_read_b128 v[60:63], v3 offset:11264
    v_mfma_f32_16x16x32_bf16 v[20:23], v[76:79], v[188:191], v[20:23]
    ds_read_b128 v[64:67], v4 offset:10240
    v_mfma_f32_16x16x32_bf16 v[24:27], v[80:83], v[184:187], v[24:27]
    ds_read_b128 v[68:71], v4 offset:11264
    v_mfma_f32_16x16x32_bf16 v[28:31], v[80:83], v[188:191], v[28:31]
    ds_read_b128 v[72:75], v5 offset:14336
    v_mfma_f32_16x16x32_bf16 v[32:35], v[84:87], v[184:187], v[32:35]
    v_mfma_f32_16x16x32_bf16 v[36:39], v[84:87], v[188:191], v[36:39]
    s_add_u32 s57, s59, 16384
    buffer_load_dwordx4 v[232:235], v2, s[24:27], s57 offen offset:1024 sc1
    s_add_u32 s57, s59, 65536
    buffer_load_dwordx4 v[236:239], v2, s[24:27], s57 offen offset:1024 sc1
    v_mfma_f32_16x16x32_bf16 v[40:43], v[88:91], v[184:187], v[40:43]
    v_mfma_f32_16x16x32_bf16 v[44:47], v[88:91], v[188:191], v[44:47]
    v_mfma_f32_16x16x32_bf16 v[48:51], v[92:95], v[184:187], v[48:51]
    v_mfma_f32_16x16x32_bf16 v[52:55], v[92:95], v[188:191], v[52:55]
    s_waitcnt vmcnt(10) lgkmcnt(0)
    ds_read_b128 v[76:79], v3 offset:20480
    v_mfma_f32_16x16x32_bf16 v[16:19], v[56:59], v[192:195], v[16:19]
    ds_read_b128 v[80:83], v3 offset:21504
    v_mfma_f32_16x16x32_bf16 v[20:23], v[56:59], v[196:199], v[20:23]
    ds_read_b128 v[84:87], v4 offset:20480
    v_mfma_f32_16x16x32_bf16 v[24:27], v[60:63], v[192:195], v[24:27]
    ds_read_b128 v[88:91], v4 offset:21504
    v_mfma_f32_16x16x32_bf16 v[28:31], v[60:63], v[196:199], v[28:31]
    ds_read_b128 v[92:95], v5 offset:24576
    v_mfma_f32_16x16x32_bf16 v[32:35], v[64:67], v[192:195], v[32:35]
    v_mfma_f32_16x16x32_bf16 v[36:39], v[64:67], v[196:199], v[36:39]
    s_add_u32 s57, s59, 16384
    buffer_load_dwordx4 v[240:243], v2, s[24:27], s57 offen offset:2048 sc1
    s_add_u32 s57, s59, 65536
    buffer_load_dwordx4 v[244:247], v2, s[24:27], s57 offen offset:2048 sc1
    v_mfma_f32_16x16x32_bf16 v[40:43], v[68:71], v[192:195], v[40:43]
    v_mfma_f32_16x16x32_bf16 v[44:47], v[68:71], v[196:199], v[44:47]
    v_mfma_f32_16x16x32_bf16 v[48:51], v[72:75], v[192:195], v[48:51]
    v_mfma_f32_16x16x32_bf16 v[52:55], v[72:75], v[196:199], v[52:55]
    s_waitcnt vmcnt(10) lgkmcnt(0)
    ds_read_b128 v[56:59], v3 offset:30720
    v_mfma_f32_16x16x32_bf16 v[16:19], v[76:79], v[200:203], v[16:19]
    ds_read_b128 v[60:63], v3 offset:31744
    v_mfma_f32_16x16x32_bf16 v[20:23], v[76:79], v[204:207], v[20:23]
    ds_read_b128 v[64:67], v4 offset:30720
    v_mfma_f32_16x16x32_bf16 v[24:27], v[80:83], v[200:203], v[24:27]
    ds_read_b128 v[68:71], v4 offset:31744
    v_mfma_f32_16x16x32_bf16 v[28:31], v[80:83], v[204:207], v[28:31]
    ds_read_b128 v[72:75], v5 offset:34816
    v_mfma_f32_16x16x32_bf16 v[32:35], v[84:87], v[200:203], v[32:35]
    v_mfma_f32_16x16x32_bf16 v[36:39], v[84:87], v[204:207], v[36:39]
    s_add_u32 s57, s59, 16384
    buffer_load_dwordx4 v[248:251], v2, s[24:27], s57 offen offset:3072 sc1
    s_add_u32 s57, s59, 65536
    buffer_load_dwordx4 v[252:255], v2, s[24:27], s57 offen offset:3072 sc1
    v_mfma_f32_16x16x32_bf16 v[40:43], v[88:91], v[200:203], v[40:43]
    v_mfma_f32_16x16x32_bf16 v[44:47], v[88:91], v[204:207], v[44:47]
    v_mfma_f32_16x16x32_bf16 v[48:51], v[92:95], v[200:203], v[48:51]
    v_mfma_f32_16x16x32_bf16 v[52:55], v[92:95], v[204:207], v[52:55]
    s_waitcnt vmcnt(10) lgkmcnt(0)
    ds_read_b128 v[76:79], v3 offset:40960
    v_mfma_f32_16x16x32_bf16 v[16:19], v[56:59], v[208:211], v[16:19]
    ds_read_b128 v[80:83], v3 offset:41984
    v_mfma_f32_16x16x32_bf16 v[20:23], v[56:59], v[212:215], v[20:23]
    ds_read_b128 v[84:87], v4 offset:40960
    v_mfma_f32_16x16x32_bf16 v[24:27], v[60:63], v[208:211], v[24:27]
    ds_read_b128 v[88:91], v4 offset:41984
    v_mfma_f32_16x16x32_bf16 v[28:31], v[60:63], v[212:215], v[28:31]
    ds_read_b128 v[92:95], v5 offset:45056
    v_mfma_f32_16x16x32_bf16 v[32:35], v[64:67], v[208:211], v[32:35]
    v_mfma_f32_16x16x32_bf16 v[36:39], v[64:67], v[212:215], v[36:39]
    s_add_u32 s57, s59, 20480
    buffer_load_dwordx4 v[96:99], v2, s[24:27], s57 offen offset:0 sc1
    s_add_u32 s57, s59, 69632
    buffer_load_dwordx4 v[100:103], v2, s[24:27], s57 offen offset:0 sc1
    v_mfma_f32_16x16x32_bf16 v[40:43], v[68:71], v[208:211], v[40:43]
    v_mfma_f32_16x16x32_bf16 v[44:47], v[68:71], v[212:215], v[44:47]
    v_mfma_f32_16x16x32_bf16 v[48:51], v[72:75], v[208:211], v[48:51]
    v_mfma_f32_16x16x32_bf16 v[52:55], v[72:75], v[212:215], v[52:55]
    s_barrier
    s_waitcnt vmcnt(10) lgkmcnt(0)
    ds_read_b128 v[56:59], v9 offset:0
    v_mfma_f32_16x16x32_bf16 v[16:19], v[76:79], v[216:219], v[16:19]
    ds_read_b128 v[60:63], v9 offset:1024
    v_mfma_f32_16x16x32_bf16 v[20:23], v[76:79], v[220:223], v[20:23]
    ds_read_b128 v[64:67], v14 offset:0
    v_mfma_f32_16x16x32_bf16 v[24:27], v[80:83], v[216:219], v[24:27]
    ds_read_b128 v[68:71], v14 offset:1024
    v_mfma_f32_16x16x32_bf16 v[28:31], v[80:83], v[220:223], v[28:31]
    ds_read_b128 v[72:75], v0 offset:4096
    v_mfma_f32_16x16x32_bf16 v[32:35], v[84:87], v[216:219], v[32:35]
    v_mfma_f32_16x16x32_bf16 v[36:39], v[84:87], v[220:223], v[36:39]
    s_add_u32 s57, s59, 20480
    buffer_load_dwordx4 v[104:107], v2, s[24:27], s57 offen offset:1024 sc1
    s_add_u32 s57, s59, 69632
    buffer_load_dwordx4 v[108:111], v2, s[24:27], s57 offen offset:1024 sc1
    v_mfma_f32_16x16x32_bf16 v[40:43], v[88:91], v[216:219], v[40:43]
    v_mfma_f32_16x16x32_bf16 v[44:47], v[88:91], v[220:223], v[44:47]
    v_mfma_f32_16x16x32_bf16 v[48:51], v[92:95], v[216:219], v[48:51]
    v_mfma_f32_16x16x32_bf16 v[52:55], v[92:95], v[220:223], v[52:55]
    s_waitcnt vmcnt(10) lgkmcnt(0)
    ds_read_b128 v[76:79], v9 offset:10240
    v_mfma_f32_16x16x32_bf16 v[16:19], v[56:59], v[224:227], v[16:19]
    ds_read_b128 v[80:83], v9 offset:11264
    v_mfma_f32_16x16x32_bf16 v[20:23], v[56:59], v[228:231], v[20:23]
    ds_read_b128 v[84:87], v14 offset:10240
    v_mfma_f32_16x16x32_bf16 v[24:27], v[60:63], v[224:227], v[24:27]
    ds_read_b128 v[88:91], v14 offset:11264
    v_mfma_f32_16x16x32_bf16 v[28:31], v[60:63], v[228:231], v[28:31]
    ds_read_b128 v[92:95], v0 offset:14336
    v_mfma_f32_16x16x32_bf16 v[32:35], v[64:67], v[224:227], v[32:35]
    v_mfma_f32_16x16x32_bf16 v[36:39], v[64:67], v[228:231], v[36:39]
    s_add_u32 s57, s59, 20480
    buffer_load_dwordx4 v[112:115], v2, s[24:27], s57 offen offset:2048 sc1
    s_add_u32 s57, s59, 69632
    buffer_load_dwordx4 v[116:119], v2, s[24:27], s57 offen offset:2048 sc1
    v_mfma_f32_16x16x32_bf16 v[40:43], v[68:71], v[224:227], v[40:43]
    v_mfma_f32_16x16x32_bf16 v[44:47], v[68:71], v[228:231], v[44:47]
    v_mfma_f32_16x16x32_bf16 v[48:51], v[72:75], v[224:227], v[48:51]
    v_mfma_f32_16x16x32_bf16 v[52:55], v[72:75], v[228:231], v[52:55]
    s_waitcnt vmcnt(10) lgkmcnt(0)
    ds_read_b128 v[56:59], v9 offset:20480
    v_mfma_f32_16x16x32_bf16 v[16:19], v[76:79], v[232:235], v[16:19]
    ds_read_b128 v[60:63], v9 offset:21504
    v_mfma_f32_16x16x32_bf16 v[20:23], v[76:79], v[236:239], v[20:23]
    ds_read_b128 v[64:67], v14 offset:20480
    v_mfma_f32_16x16x32_bf16 v[24:27], v[80:83], v[232:235], v[24:27]
    ds_read_b128 v[68:71], v14 offset:21504
    v_mfma_f32_16x16x32_bf16 v[28:31], v[80:83], v[236:239], v[28:31]
    ds_read_b128 v[72:75], v0 offset:24576
    v_mfma_f32_16x16x32_bf16 v[32:35], v[84:87], v[232:235], v[32:35]
    v_mfma_f32_16x16x32_bf16 v[36:39], v[84:87], v[236:239], v[36:39]
    s_add_u32 s57, s59, 20480
    buffer_load_dwordx4 v[120:123], v2, s[24:27], s57 offen offset:3072 sc1
    s_add_u32 s57, s59, 69632
    buffer_load_dwordx4 v[124:127], v2, s[24:27], s57 offen offset:3072 sc1
    v_mfma_f32_16x16x32_bf16 v[40:43], v[88:91], v[232:235], v[40:43]
    v_mfma_f32_16x16x32_bf16 v[44:47], v[88:91], v[236:239], v[44:47]
    v_mfma_f32_16x16x32_bf16 v[48:51], v[92:95], v[232:235], v[48:51]
    v_mfma_f32_16x16x32_bf16 v[52:55], v[92:95], v[236:239], v[52:55]
    s_waitcnt vmcnt(10) lgkmcnt(0)
    ds_read_b128 v[76:79], v9 offset:30720
    v_mfma_f32_16x16x32_bf16 v[16:19], v[56:59], v[240:243], v[16:19]
    ds_read_b128 v[80:83], v9 offset:31744
    v_mfma_f32_16x16x32_bf16 v[20:23], v[56:59], v[244:247], v[20:23]
    ds_read_b128 v[84:87], v14 offset:30720
    v_mfma_f32_16x16x32_bf16 v[24:27], v[60:63], v[240:243], v[24:27]
    ds_read_b128 v[88:91], v14 offset:31744
    v_mfma_f32_16x16x32_bf16 v[28:31], v[60:63], v[244:247], v[28:31]
    ds_read_b128 v[92:95], v0 offset:34816
    v_mfma_f32_16x16x32_bf16 v[32:35], v[64:67], v[240:243], v[32:35]
    v_mfma_f32_16x16x32_bf16 v[36:39], v[64:67], v[244:247], v[36:39]
    v_mfma_f32_16x16x32_bf16 v[40:43], v[68:71], v[240:243], v[40:43]
    v_mfma_f32_16x16x32_bf16 v[44:47], v[68:71], v[244:247], v[44:47]
    v_mfma_f32_16x16x32_bf16 v[48:51], v[72:75], v[240:243], v[48:51]
    v_mfma_f32_16x16x32_bf16 v[52:55], v[72:75], v[244:247], v[52:55]
    s_waitcnt vmcnt(8) lgkmcnt(0)
    ds_read_b128 v[56:59], v6 offset:30720
    v_mfma_f32_16x16x32_bf16 v[16:19], v[76:79], v[248:251], v[16:19]
    ds_read_b128 v[60:63], v6 offset:31744
    v_mfma_f32_16x16x32_bf16 v[20:23], v[76:79], v[252:255], v[20:23]
    ds_read_b128 v[64:67], v7 offset:30720
    v_mfma_f32_16x16x32_bf16 v[24:27], v[80:83], v[248:251], v[24:27]
    ds_read_b128 v[68:71], v7 offset:31744
    v_mfma_f32_16x16x32_bf16 v[28:31], v[80:83], v[252:255], v[28:31]
    ds_read_b128 v[72:75], v8 offset:34816
    v_mfma_f32_16x16x32_bf16 v[32:35], v[84:87], v[248:251], v[32:35]
    v_mfma_f32_16x16x32_bf16 v[36:39], v[84:87], v[252:255], v[36:39]
    v_mfma_f32_16x16x32_bf16 v[40:43], v[88:91], v[248:251], v[40:43]
    v_mfma_f32_16x16x32_bf16 v[44:47], v[88:91], v[252:255], v[44:47]
    v_mfma_f32_16x16x32_bf16 v[48:51], v[92:95], v[248:251], v[48:51]
    v_mfma_f32_16x16x32_bf16 v[52:55], v[92:95], v[252:255], v[52:55]
    s_waitcnt vmcnt(6) lgkmcnt(0)
    ds_read_b128 v[76:79], v6 offset:40960
    v_mfma_f32_16x16x32_bf16 v[16:19], v[56:59], v[96:99], v[16:19]
    ds_read_b128 v[80:83], v6 offset:41984
    v_mfma_f32_16x16x32_bf16 v[20:23], v[56:59], v[100:103], v[20:23]
    ds_read_b128 v[84:87], v7 offset:40960
    v_mfma_f32_16x16x32_bf16 v[24:27], v[60:63], v[96:99], v[24:27]
    ds_read_b128 v[88:91], v7 offset:41984
    v_mfma_f32_16x16x32_bf16 v[28:31], v[60:63], v[100:103], v[28:31]
    ds_read_b128 v[92:95], v8 offset:45056
    v_mfma_f32_16x16x32_bf16 v[32:35], v[64:67], v[96:99], v[32:35]
    v_mfma_f32_16x16x32_bf16 v[36:39], v[64:67], v[100:103], v[36:39]
    v_mfma_f32_16x16x32_bf16 v[40:43], v[68:71], v[96:99], v[40:43]
    v_mfma_f32_16x16x32_bf16 v[44:47], v[68:71], v[100:103], v[44:47]
    v_mfma_f32_16x16x32_bf16 v[48:51], v[72:75], v[96:99], v[48:51]
    v_mfma_f32_16x16x32_bf16 v[52:55], v[72:75], v[100:103], v[52:55]
    s_waitcnt vmcnt(4) lgkmcnt(0)
    ds_read_b128 v[56:59], v6 offset:51200
    v_mfma_f32_16x16x32_bf16 v[16:19], v[76:79], v[104:107], v[16:19]
    ds_read_b128 v[60:63], v6 offset:52224
    v_mfma_f32_16x16x32_bf16 v[20:23], v[76:79], v[108:111], v[20:23]
    ds_read_b128 v[64:67], v7 offset:51200
    v_mfma_f32_16x16x32_bf16 v[24:27], v[80:83], v[104:107], v[24:27]
    ds_read_b128 v[68:71], v7 offset:52224
    v_mfma_f32_16x16x32_bf16 v[28:31], v[80:83], v[108:111], v[28:31]
    ds_read_b128 v[72:75], v8 offset:55296
    v_mfma_f32_16x16x32_bf16 v[32:35], v[84:87], v[104:107], v[32:35]
    v_mfma_f32_16x16x32_bf16 v[36:39], v[84:87], v[108:111], v[36:39]
    v_mfma_f32_16x16x32_bf16 v[40:43], v[88:91], v[104:107], v[40:43]
    v_mfma_f32_16x16x32_bf16 v[44:47], v[88:91], v[108:111], v[44:47]
    v_mfma_f32_16x16x32_bf16 v[48:51], v[92:95], v[104:107], v[48:51]
    v_mfma_f32_16x16x32_bf16 v[52:55], v[92:95], v[108:111], v[52:55]
    s_waitcnt vmcnt(2) lgkmcnt(0)
    ds_read_b128 v[84:87], v4 offset:51200
    v_mfma_f32_16x16x32_bf16 v[32:35], v[64:67], v[112:115], v[32:35]
    ds_read_b128 v[88:91], v4 offset:52224
    v_mfma_f32_16x16x32_bf16 v[36:39], v[64:67], v[116:119], v[36:39]
    ds_read_b128 v[92:95], v5 offset:55296
    v_mfma_f32_16x16x32_bf16 v[40:43], v[68:71], v[112:115], v[40:43]
    ds_read_b128 v[76:79], v3 offset:51200
    v_mfma_f32_16x16x32_bf16 v[44:47], v[68:71], v[116:119], v[44:47]
    ds_read_b128 v[80:83], v3 offset:52224
    v_mfma_f32_16x16x32_bf16 v[48:51], v[72:75], v[112:115], v[48:51]
    v_mfma_f32_16x16x32_bf16 v[52:55], v[72:75], v[116:119], v[52:55]
    v_mfma_f32_16x16x32_bf16 v[16:19], v[56:59], v[112:115], v[16:19]
    v_mfma_f32_16x16x32_bf16 v[20:23], v[56:59], v[116:119], v[20:23]
    s_waitcnt vmcnt(0) lgkmcnt(2)
    v_mfma_f32_16x16x32_bf16 v[32:35], v[84:87], v[120:123], v[32:35]
    v_mfma_f32_16x16x32_bf16 v[36:39], v[84:87], v[124:127], v[36:39]
    v_mfma_f32_16x16x32_bf16 v[40:43], v[88:91], v[120:123], v[40:43]
    v_mfma_f32_16x16x32_bf16 v[44:47], v[88:91], v[124:127], v[44:47]
    v_mfma_f32_16x16x32_bf16 v[48:51], v[92:95], v[120:123], v[48:51]
    v_mfma_f32_16x16x32_bf16 v[52:55], v[92:95], v[124:127], v[52:55]
    v_and_b32 v6, 31, v1
    v_mul_u32_u24 v6, 1280, v6
    s_waitcnt lgkmcnt(0)
    v_mfma_f32_16x16x32_bf16 v[24:27], v[60:63], v[112:115], v[24:27]
    ds_write_b128 v10, v[32:35] offset:0
    v_mfma_f32_16x16x32_bf16 v[28:31], v[60:63], v[116:119], v[28:31]
    ds_write_b128 v10, v[36:39] offset:1024
    v_mfma_f32_16x16x32_bf16 v[16:19], v[76:79], v[120:123], v[16:19]
    ds_write_b128 v10, v[40:43] offset:2048
    v_mfma_f32_16x16x32_bf16 v[20:23], v[76:79], v[124:127], v[20:23]
    ds_write_b128 v10, v[44:47] offset:3072
    v_mfma_f32_16x16x32_bf16 v[24:27], v[80:83], v[120:123], v[24:27]
    ds_write_b128 v12, v[48:51] offset:0
    v_mfma_f32_16x16x32_bf16 v[28:31], v[80:83], v[124:127], v[28:31]
    ds_write_b128 v12, v[52:55] offset:1024
    v_lshrrev_b32 v7, 5, v1
    v_lshl_add_u32 v6, v7, 4, v6
    s_mul_i32 s52, s54, 20480
    s_add_u32 s52, s52, s97
    s_lshl_b32 s53, s55, 6
    s_add_u32 s53, s53, s52
    s_waitcnt lgkmcnt(0)
    s_barrier
    ds_read_b128 v[96:99], v11 offset:0
    ds_read_b128 v[100:103], v11 offset:1024
    ds_read_b128 v[104:107], v11 offset:2048
    ds_read_b128 v[108:111], v11 offset:3072
    ds_read_b128 v[112:115], v13 offset:0
    ds_read_b128 v[116:119], v13 offset:1024
    s_waitcnt lgkmcnt(4)
    v_pk_add_f32 v[16:17], v[16:17], v[96:97]
    v_pk_add_f32 v[18:19], v[18:19], v[98:99]
    v_cvt_pk_bf16_f32 v128, v16, v17
    v_cvt_pk_bf16_f32 v129, v18, v19
    v_pk_add_f32 v[20:21], v[20:21], v[100:101]
    v_pk_add_f32 v[22:23], v[22:23], v[102:103]
    v_cvt_pk_bf16_f32 v130, v20, v21
    v_cvt_pk_bf16_f32 v131, v22, v23
    s_nop 0
    v_permlane16_swap_b32 v128, v130
    v_permlane16_swap_b32 v129, v131
    buffer_store_dwordx4 v[128:131], v6, s[28:31], s53 offen offset:0
    s_waitcnt lgkmcnt(2)
    v_pk_add_f32 v[24:25], v[24:25], v[104:105]
    v_pk_add_f32 v[26:27], v[26:27], v[106:107]
    v_cvt_pk_bf16_f32 v132, v24, v25
    v_cvt_pk_bf16_f32 v133, v26, v27
    v_pk_add_f32 v[28:29], v[28:29], v[108:109]
    v_pk_add_f32 v[30:31], v[30:31], v[110:111]
    v_cvt_pk_bf16_f32 v134, v28, v29
    v_cvt_pk_bf16_f32 v135, v30, v31
    s_nop 0
    v_permlane16_swap_b32 v132, v134
    v_permlane16_swap_b32 v133, v135
    buffer_store_dwordx4 v[132:135], v6, s[28:31], s53 offen offset:32
    s_waitcnt lgkmcnt(0)
    s_cmp_lg_u32 s55, 0
    s_cbranch_scc1 L_fin
    v_pk_add_f32 v[48:49], v[48:49], v[112:113]
    v_pk_add_f32 v[50:51], v[50:51], v[114:115]
    v_cvt_pk_bf16_f32 v136, v48, v49
    v_cvt_pk_bf16_f32 v137, v50, v51
    v_pk_add_f32 v[52:53], v[52:53], v[116:117]
    v_pk_add_f32 v[54:55], v[54:55], v[118:119]
    v_cvt_pk_bf16_f32 v138, v52, v53
    v_cvt_pk_bf16_f32 v139, v54, v55
    s_nop 0
    v_permlane16_swap_b32 v136, v138
    v_permlane16_swap_b32 v137, v139
    buffer_store_dwordx4 v[136:139], v6, s[28:31], s52 offen offset:128
    s_branch L_fin
L_E_help:
    s_mov_b32 s55, s46
    s_and_b32 s52, s55, 1
    s_lshr_b32 s53, s55, 1
    s_mul_i32 s57, s52, 24
    s_add_u32 s57, s57, s53
    s_mul_i32 s57, s57, 5120
    s_add_u32 s57, s57, s69
    s_mul_i32 s52, s46, 5120
    v_add_u32 v3, s52, v2
    ds_write_b128 v3, v[136:139] offset:51200
    ds_write_b128 v3, v[176:179] offset:52224
    ds_write_b128 v3, v[216:219] offset:53248
    ds_write_b128 v3, v[140:143] offset:54272
    ds_write_b128 v3, v[180:183] offset:55296
    ds_write_b128 v3, v[220:223] offset:0
    ds_write_b128 v3, v[144:147] offset:1024
    ds_write_b128 v3, v[184:187] offset:2048
    ds_write_b128 v3, v[224:227] offset:3072
    ds_write_b128 v3, v[148:151] offset:4096
    s_cmp_ge_u32 s46, 2
    s_cbranch_scc1 Le15_68
    ds_write_b128 v3, v[188:191] offset:40960
    ds_write_b128 v3, v[228:231] offset:41984
    ds_write_b128 v3, v[152:155] offset:43008
    ds_write_b128 v3, v[192:195] offset:44032
    ds_write_b128 v3, v[232:235] offset:45056
Le15_68:
    s_add_u32 s53, s57, 112640
    buffer_load_dwordx4 v[16:19], v2, s[24:27], s53 offen sc1
    s_add_u32 s53, s57, 113664
    buffer_load_dwordx4 v[20:23], v2, s[24:27], s53 offen sc1
    s_add_u32 s53, s57, 114688
    buffer_load_dwordx4 v[24:27], v2, s[24:27], s53 offen sc1
    s_add_u32 s53, s57, 115712
    buffer_load_dwordx4 v[28:31], v2, s[24:27], s53 offen sc1
    s_add_u32 s53, s57, 116736
    buffer_load_dwordx4 v[32:35], v2, s[24:27], s53 offen sc1
    s_mul_i32 s58, s55, 5120
    v_add_u32 v8, s58, v2
    v_add_u32 v9, 122880, v8
    v_add_u32 v10, 92160, v8
    s_and_b32 s52, s55, 1
    s_mul_i32 s52, s52, 5120
    s_cmp_ge_u32 s55, 2
    s_cselect_b32 s53, 51200, 0
    s_cselect_b32 s54, 0, 1
    s_mul_i32 s54, s54, 112640
    s_add_u32 s52, s52, s53
    s_add_u32 s52, s52, s54
    v_add_u32 v11, s52, v2
    s_waitcnt lgkmcnt(0)
    s_barrier
    s_waitcnt vmcnt(0)
    ds_write_b128 v9, v[156:159] offset:0
    s_waitcnt lgkmcnt(0)
    ds_write_b128 v9, v[196:199] offset:1024
    s_waitcnt lgkmcnt(0)
    ds_write_b128 v9, v[236:239] offset:2048
    s_waitcnt lgkmcnt(0)
    ds_write_b128 v9, v[160:163] offset:3072
    s_waitcnt lgkmcnt(0)
    ds_write_b128 v9, v[200:203] offset:4096
    s_waitcnt lgkmcnt(0)
    ds_write_b128 v9, v[240:243] offset:20480
    s_waitcnt lgkmcnt(0)
    ds_write_b128 v9, v[164:167] offset:21504
    s_waitcnt lgkmcnt(0)
    ds_write_b128 v9, v[204:207] offset:22528
    s_waitcnt lgkmcnt(0)
    ds_write_b128 v9, v[244:247] offset:23552
    s_waitcnt lgkmcnt(0)
    ds_write_b128 v9, v[168:171] offset:24576
    s_waitcnt lgkmcnt(0)
    s_waitcnt lgkmcnt(0)
    s_barrier
    ds_write_b128 v10, v[208:211] offset:0
    s_waitcnt lgkmcnt(0)
    ds_write_b128 v10, v[248:251] offset:1024
    s_waitcnt lgkmcnt(0)
    ds_write_b128 v10, v[172:175] offset:2048
    s_waitcnt lgkmcnt(0)
    ds_write_b128 v10, v[212:215] offset:3072
    s_waitcnt lgkmcnt(0)
    ds_write_b128 v10, v[252:255] offset:4096
    s_waitcnt lgkmcnt(0)
    ds_write_b128 v11, v[16:19] offset:0
    s_waitcnt lgkmcnt(0)
    ds_write_b128 v11, v[20:23] offset:1024
    s_waitcnt lgkmcnt(0)
    ds_write_b128 v11, v[24:27] offset:2048
    s_waitcnt lgkmcnt(0)
    ds_write_b128 v11, v[28:31] offset:3072
    s_waitcnt lgkmcnt(0)
    ds_write_b128 v11, v[32:35] offset:4096
    s_waitcnt lgkmcnt(0)
    s_waitcnt lgkmcnt(0)
    s_barrier
    s_barrier
L_fin:
    s_or_b32 s52, s2, s46
    s_cmp_lg_u32 s52, 0
    s_cbranch_scc1 Lz_69
    v_mov_b32 v10, 0
    v_mov_b32 v11, 0
    s_mov_b64 exec, 1
    buffer_store_dwordx2 v[10:11], v10, s[32:35], 0 offen sc1
    s_mov_b64 exec, -1
Lz_69:
    s_waitcnt vmcnt(0)
L_end:
    s_endpgm
Lnon_4_again:
    s_add_u32 s94, s94, 1
    s_cmp_gt_u32 s94, 0x40000
    s_cbranch_scc1 Lnone_5
    v_mov_b32 v246, 0
    buffer_load_dwordx2 v[250:251], v246, s[32:35], 0 offen sc1
    s_branch Lnon_4
Lnon_7_again:
    s_add_u32 s94, s94, 1
    s_cmp_gt_u32 s94, 0x40000
    s_cbranch_scc1 Lnone_8
    v_mov_b32 v246, 0
    buffer_load_dwordx2 v[250:251], v246, s[32:35], 0 offen sc1
    s_branch Lnon_7
L_B_slow:
    v_and_b32 v5, 31, v1
    v_lshlrev_b32 v5, 3, v5
    v_lshrrev_b32 v3, 5, v1
    v_mul_u32_u24 v3, 33280, v3
    v_add_u32 v3, v3, v5
    v_lshrrev_b32 v6, 4, v1
    v_and_b32 v7, 15, v1
    v_lshlrev_b32 v7, 4, v7
    v_mul_u32_u24 v6, 16640, v6
    v_add_u32 v6, v6, v7
    s_xor_b32 s58, s46, 4
    s_lshl_b32 s58, s58, 12
    s_add_u32 s58, s58, 120064
    v_and_b32 v116, 3, v1
    v_bfe_u32 v117, v1, 4, 1
    v_lshl_add_u32 v116, v117, 2, v116
    v_lshlrev_b32 v7, 8, v116
    v_add_u32 v7, s58, v7
    v_cmp_lt_u32 vcc, 4, v116
    v_mov_b32 v116, 161696
    s_nop 0
    v_cndmask_b32 v7, v7, v116, vcc
    v_bfe_u32 v116, v1, 2, 2
    v_lshrrev_b32 v117, 5, v1
    v_lshl_add_u32 v116, v117, 3, v116
    v_lshl_add_u32 v7, v116, 3, v7
    v_mov_b32 v116, 0xff800000
    s_add_u32 s55, s62, 160
    s_mul_i32 s55, s55, 16640
    s_add_u32 s56, s55, 2662400
    s_mov_b32 s57, 0
L_B_slow0:
    buffer_load_dwordx2 v[48:49], v3, s[24:27], s55 offen sc1
    s_add_u32 s59, s55, 16640
    buffer_load_dwordx2 v[50:51], v3, s[24:27], s59 offen sc1
    s_add_u32 s59, s55, 66560
    buffer_load_dwordx2 v[52:53], v5, s[24:27], s59 offen sc1
    s_waitcnt vmcnt(0)
    v_mfma_f32_32x32x8_bf16 v[80:95], v[52:53], v[28:29], 0
    v_mfma_f32_32x32x16_bf16 v[80:95], v[48:51], v[20:23], v[80:95]
    s_nop 11
    v_max3_f32 v116, v116, v80, v81
    v_max3_f32 v116, v116, v82, v83
    v_max3_f32 v116, v116, v84, v85
    v_max3_f32 v116, v116, v86, v87
    v_max3_f32 v116, v116, v88, v89
    v_max3_f32 v116, v116, v90, v91
    v_max3_f32 v116, v116, v92, v93
    v_max3_f32 v116, v116, v94, v95
    s_add_u32 s55, s55, 256
    s_add_u32 s56, s56, 256
    s_add_u32 s57, s57, 1
    s_cmp_lt_u32 s57, 64
    s_cbranch_scc1 L_B_slow0
    v_mov_b32 v117, v116
    s_nop 1
    v_permlane32_swap_b32 v116, v117
    v_max_f32 v116, v116, v117
    v_sub_f32 v32, 0, v116
    v_mov_b32 v64, 0
    v_sub_f32 v33, 0, v116
    v_mov_b32 v65, 0
    v_sub_f32 v34, 0, v116
    v_mov_b32 v66, 0
    v_sub_f32 v35, 0, v116
    v_mov_b32 v67, 0
    v_sub_f32 v36, 0, v116
    v_mov_b32 v68, 0
    v_sub_f32 v37, 0, v116
    v_mov_b32 v69, 0
    v_sub_f32 v38, 0, v116
    v_mov_b32 v70, 0
    v_sub_f32 v39, 0, v116
    v_mov_b32 v71, 0
    v_sub_f32 v40, 0, v116
    v_mov_b32 v72, 0
    v_sub_f32 v41, 0, v116
    v_mov_b32 v73, 0
    v_sub_f32 v42, 0, v116
    v_mov_b32 v74, 0
    v_sub_f32 v43, 0, v116
    v_mov_b32 v75, 0
    v_sub_f32 v44, 0, v116
    v_mov_b32 v76, 0
    v_sub_f32 v45, 0, v116
    v_mov_b32 v77, 0
    v_sub_f32 v46, 0, v116
    v_mov_b32 v78, 0
    v_sub_f32 v47, 0, v116
    v_mov_b32 v79, 0
    s_add_u32 s55, s62, 160
    s_mul_i32 s55, s55, 16640
    s_add_u32 s56, s55, 2662400
    s_mov_b32 s57, 0
L_B_slow1:
    buffer_load_dwordx2 v[48:49], v3, s[24:27], s55 offen sc1
    s_add_u32 s59, s55, 16640
    buffer_load_dwordx2 v[50:51], v3, s[24:27], s59 offen sc1
    s_add_u32 s59, s55, 66560
    buffer_load_dwordx2 v[52:53], v5, s[24:27], s59 offen sc1
    s_mov_b32 m0, s58
    s_nop 0
    buffer_load_dwordx4 v6, s[24:27], s56 offen sc1 lds
    s_add_u32 m0, s58, 1024
    s_add_u32 s59, s56, 66560
    s_mov_b64 exec, 0xffff
    buffer_load_dwordx4 v6, s[24:27], s59 offen sc1 lds
    s_mov_b64 exec, -1
    s_waitcnt vmcnt(0)
    ds_read_b64_tr_b16 v[56:57], v7 offset:0
    ds_read_b64_tr_b16 v[58:59], v7 offset:32
    ds_read_b64_tr_b16 v[60:61], v7 offset:128
    ds_read_b64_tr_b16 v[62:63], v7 offset:160
    v_mfma_f32_32x32x8_bf16 v[80:95], v[52:53], v[28:29], v[32:47]
    v_mfma_f32_32x32x16_bf16 v[80:95], v[48:51], v[20:23], v[80:95]
    s_nop 11
    v_exp_f32 v80, v80
    v_exp_f32 v81, v81
    v_exp_f32 v82, v82
    v_exp_f32 v83, v83
    v_exp_f32 v84, v84
    v_exp_f32 v85, v85
    v_exp_f32 v86, v86
    v_exp_f32 v87, v87
    v_exp_f32 v88, v88
    v_exp_f32 v89, v89
    v_exp_f32 v90, v90
    v_exp_f32 v91, v91
    v_exp_f32 v92, v92
    v_exp_f32 v93, v93
    v_exp_f32 v94, v94
    v_exp_f32 v95, v95
    s_waitcnt lgkmcnt(0)
    v_smfmac_f32_32x32x32_bf16 v[64:79], v[56:59], v[80:87], v8
    v_smfmac_f32_32x32x32_bf16 v[64:79], v[60:63], v[88:95], v8
    s_add_u32 s55, s55, 256
    s_add_u32 s56, s56, 256
    s_add_u32 s57, s57, 1
    s_cmp_lt_u32 s57, 64
    s_cbranch_scc1 L_B_slow1
    s_nop 6
    v_rcp_f32 v116, v76
    s_nop 0
    v_mul_f32 v64, v64, v116
    v_mul_f32 v65, v65, v116
    v_mul_f32 v66, v66, v116
    v_mul_f32 v67, v67, v116
    v_mul_f32 v68, v68, v116
    v_mul_f32 v69, v69, v116
    v_mul_f32 v70, v70, v116
    v_mul_f32 v71, v71, v116
    v_mul_f32 v72, v72, v116
    v_mul_f32 v73, v73, v116
    v_mul_f32 v74, v74, v116
    v_mul_f32 v75, v75, v116
    s_mov_b32 s78, 1
    s_branch L_B_back
.section .rodata,"a"
.p2align 6
.amdhsa_kernel sequential_preLN__mha_block__dense_activation_squared_relu__prompt_kernel
  .amdhsa_next_free_vgpr 256
  .amdhsa_next_free_sgpr 102
  .amdhsa_accum_offset 256
  .amdhsa_group_segment_fixed_size 0
  .amdhsa_kernarg_size 88
  .amdhsa_user_sgpr_count 2
  .amdhsa_user_sgpr_kernarg_segment_ptr 1
  .amdhsa_system_sgpr_workgroup_id_x 1
.end_amdhsa_kernel
```
